```python
import torch

def _softmax(x, axis=-1):
    return torch.softmax(x, dim=axis)
def _gelu(x):
    return torch.nn.functional.gelu(x, approximate="tanh")
def _silu(x):
    return torch.nn.functional.silu(x)
def _sigmoid(x):
    return torch.sigmoid(x)
def _layernorm(x, axis=-1, eps=1e-5):
    m = x.mean(dim=axis, keepdim=True)
    v = x.var(dim=axis, keepdim=True, unbiased=False)
    return (x - m) / torch.sqrt(v + eps)
def _scatter_add(tgt, idx, src, axis=0):
    return tgt.clone().index_add_(axis, idx, src)
def _segment_sum(src, seg, n):
    out = torch.zeros((n,) + src.shape[1:], dtype=src.dtype)
    return out.index_add_(0, seg, src)
def _pad(x, pw):
    flat = tuple(v for pair in reversed(pw) for v in pair)
    return torch.nn.functional.pad(x, flat)

kernel_name = 'interleave_layers__mha_block_cached__glu_gated_geglu__decode'

def setup_inputs():

    _w = (lambda a: (lambda t: t.to(torch.bfloat16) if t.is_floating_point() else t)(torch.as_tensor(a)))
    def _A_setup():
        B, Sq, D = 2, 1, 576
        H, Sk, Dh = 32, 8192, 128
        return {
            "x": _w((lambda *s: torch.randn(*s, dtype=torch.bfloat16) * 0.05)(B, Sq, D)),
            "k_cache": _w((lambda *s: torch.randn(*s, dtype=torch.bfloat16) * 0.8)(B, H, Sk, Dh)),
            "v_cache": _w((lambda *s: torch.randn(*s, dtype=torch.bfloat16) * 1.6)(B, H, Sk, Dh)),
            "wq": _w((lambda *s: torch.randn(*s, dtype=torch.bfloat16) * 0.8)(D, H * Dh) * (D ** -0.5)),
            "wo": _w((lambda *s: torch.randn(*s, dtype=torch.bfloat16) * 1.6)(H * Dh, D) * ((H * Dh) ** -0.5)),
        }
    _A_in = _A_setup()

    def _B_setup():
        B, S, Dm, Df = 2, 1, 576, 4608
        return {
            "x": _w((lambda *s: torch.randn(*s, dtype=torch.bfloat16) * 0.05)(B, S, Dm)),
            "w_gate": _w((lambda *s: torch.randn(*s, dtype=torch.bfloat16) * 0.8)(Dm, Df) * (Dm ** -0.5)),
            "w_up": _w((lambda *s: torch.randn(*s, dtype=torch.bfloat16) * 0.8)(Dm, Df) * (Dm ** -0.5)),
            "w_down": _w((lambda *s: torch.randn(*s, dtype=torch.bfloat16) * 0.8)(Df, Dm) * (Df ** -0.5)),
        }
    _B_in = _B_setup()

    return {
        "A_x": _A_in["x"],
        "A_k_cache": _A_in["k_cache"],
        "A_v_cache": _A_in["v_cache"],
        "A_wq": _A_in["wq"],
        "A_wo": _A_in["wo"],
        "B_x": _B_in["x"],
        "B_w_gate": _B_in["w_gate"],
        "B_w_up": _B_in["w_up"],
        "B_w_down": _B_in["w_down"],
    }

def reference(A_x, A_k_cache, A_v_cache, A_wq, A_wo, B_x, B_w_gate, B_w_up, B_w_down):
    def _A_ref(x, k_cache, v_cache, wq, wo):
        B, Sq, D = x.shape
        H, Dh = 32, 128
        q = (lambda x, *d: x.permute(*d))((x @ wq).reshape(B, Sq, H, Dh), 0, 2, 1, 3)
        scores = torch.einsum("bhqd,bhkd->bhqk", q, k_cache) * (Dh ** -0.5)
        p = _softmax(scores, axis=-1)
        o = torch.einsum("bhqk,bhkd->bhqd", p, v_cache)
        return (lambda x, *d: x.permute(*d))(o, 0, 2, 1, 3).reshape(B, Sq, H * Dh) @ wo

    def _B_ref(x, w_gate, w_up, w_down):
        g = torch.einsum("bsd,df->bsf", x, w_gate)
        u = torch.einsum("bsd,df->bsf", x, w_up)
        h = _gelu(g) * u
        return torch.einsum("bsf,fd->bsd", h, w_down)

    x = A_x
    x = x + _A_ref(_layernorm(x, axis=-1), A_k_cache, A_v_cache, A_wq, A_wo)
    x = x + _B_ref(_layernorm(x, axis=-1), B_w_gate, B_w_up, B_w_down)
    x = x + _A_ref(_layernorm(x, axis=-1), A_k_cache, A_v_cache, A_wq, A_wo)
    x = x + _B_ref(_layernorm(x, axis=-1), B_w_gate, B_w_up, B_w_down)
    return x
```

```asm
; @launch grid=(256,1,1) block=(256,1,1) lds=163840
.amdgcn_target "amdgcn-amd-amdhsa--gfx950"
.text
.globl interleave_layers__mha_block_cached__glu_gated_geglu__decode_kernel
.p2align 8
.type interleave_layers__mha_block_cached__glu_gated_geglu__decode_kernel,@function
interleave_layers__mha_block_cached__glu_gated_geglu__decode_kernel:
    s_cmp_ge_u32 s2, 256
    s_cbranch_scc1 L_exit

    s_load_dwordx16 s[48:63], s[0:1], 0
    s_load_dwordx8 s[64:71], s[0:1], 64
    v_lshrrev_b32 v2, 6, v0
    v_and_b32 v0, 63, v0
    v_readfirstlane_b32 s3, v2
    s_and_b32 s32, s2, 7
    s_lshr_b32 s33, s2, 3
    s_lshr_b32 s34, s2, 6
    s_and_b32 s35, s33, 7
    s_lshl_b32 s84, s32, 2
    s_add_u32 s84, s84, s34
    s_lshl_b32 s44, s84, 21
    s_lshl_b32 s39, s35, 18
    s_add_u32 s44, s44, s39
    s_lshl_b32 s39, s3, 12
    s_add_u32 s44, s44, s39
    s_mul_i32 s45, s3, 14336
    s_add_u32 s45, s45, 101376
    s_mov_b32 s38, 0
    s_mov_b32 s41, 0
    s_mov_b32 s47, 0
    s_mov_b32 s6, 0x8000000
    s_mov_b32 s7, 0x20000

    v_bfe_u32 v56, v0, 2, 2
    v_lshl_add_u32 v56, v56, 8, s44
    v_lshrrev_b32 v57, 4, v0
    v_lshl_add_u32 v56, v57, 6, v56
    v_and_b32 v57, 3, v0
    v_lshl_add_u32 v56, v57, 4, v56
    s_waitcnt lgkmcnt(0)
    s_mov_b32 s4, s50
    s_mov_b32 s5, s51
    s_mov_b32 s12, s70
    s_mov_b32 s13, s71
    s_mov_b32 s14, 0x20000000
    s_mov_b32 s15, 0x20000
    v_lshlrev_b32 v58, 4, v0
    s_mul_i32 s40, s2, 1136
    v_mov_b32 v60, -1
    v_mov_b32 v61, -1
    v_mov_b32 v62, -1
    v_mov_b32 v63, -1
    s_cmp_lg_u32 s3, 0
    s_cbranch_scc1 L_nors
    buffer_store_dwordx4 v[60:63], v58, s[12:15], s40 offen sc1
    s_add_u32 s40, s40, 1024
    s_mov_b32 exec_lo, 0x7f
    s_mov_b32 exec_hi, 0x0
    buffer_store_dwordx4 v[60:63], v58, s[12:15], s40 offen sc1
    s_add_u32 s40, s40, 1024
    s_mov_b64 exec, -1
L_nors:
    s_add_u32 s39, s38, 0
    buffer_load_dwordx4 a[0:3], v56, s[4:7], s39 offen offset:0 nt
    buffer_load_dwordx4 a[4:7], v56, s[4:7], s39 offen offset:1024 nt
    buffer_load_dwordx4 a[8:11], v56, s[4:7], s39 offen offset:2048 nt
    buffer_load_dwordx4 a[12:15], v56, s[4:7], s39 offen offset:3072 nt
    s_mov_b32 s8, s52
    s_mov_b32 s9, s53
    s_mov_b32 s10, 0x8000000
    s_mov_b32 s11, 0x20000
    s_mov_b32 s16, s70
    s_mov_b32 s17, s71
    s_mov_b32 s18, 0
    s_mov_b32 s19, 0x20000
    s_mov_b32 s20, s70
    s_mov_b32 s21, s71
    s_mov_b32 s22, 0
    s_mov_b32 s23, 0x20000
    s_mov_b32 s24, s66
    s_mov_b32 s25, s67
    s_mov_b32 s26, 2304
    s_mov_b32 s27, 0x20000
    s_mov_b32 s31, 0x20000
    s_add_u32 s88, s33, 1
    s_and_b32 s88, s88, 31
    s_add_u32 s89, s33, 2
    s_and_b32 s89, s89, 31
    s_mov_b32 s28, s54
    s_mov_b32 s29, s55
    s_mov_b32 s30, 4718592
    v_lshrrev_b32 v58, 1, v0
    s_mul_i32 s39, s3, 144
    v_add_u32 v58, s39, v58
    v_and_b32 v59, 1, v0
    v_lshlrev_b32 v59, 4, v59
    v_lshl_add_u32 v58, v58, 13, v59
    s_lshl_b32 s40, s84, 8
    s_lshl_b32 s39, s35, 5
    s_add_u32 s40, s40, s39
    s_mul_i32 s82, s3, 4608

    s_add_u32 m0, s82, 82944
    s_add_u32 s39, s40, 0
    buffer_load_dwordx4 v58, s[28:31], s39 offen  lds
    s_add_u32 m0, s82, 83968
    s_add_u32 s39, s40, 262144
    buffer_load_dwordx4 v58, s[28:31], s39 offen  lds
    s_add_u32 s39, s38, 16384
    buffer_load_dwordx4 a[16:19], v56, s[4:7], s39 offen offset:0 nt
    buffer_load_dwordx4 a[20:23], v56, s[4:7], s39 offen offset:1024 nt
    buffer_load_dwordx4 a[24:27], v56, s[4:7], s39 offen offset:2048 nt
    buffer_load_dwordx4 a[28:31], v56, s[4:7], s39 offen offset:3072 nt
    s_add_u32 m0, s82, 84992
    s_add_u32 s39, s40, 524288
    buffer_load_dwordx4 v58, s[28:31], s39 offen  lds
    s_add_u32 m0, s82, 86016
    s_add_u32 s39, s40, 786432
    buffer_load_dwordx4 v58, s[28:31], s39 offen  lds
    s_add_u32 s39, s38, 32768
    buffer_load_dwordx4 a[32:35], v56, s[4:7], s39 offen offset:0 nt
    buffer_load_dwordx4 a[36:39], v56, s[4:7], s39 offen offset:1024 nt
    buffer_load_dwordx4 a[40:43], v56, s[4:7], s39 offen offset:2048 nt
    buffer_load_dwordx4 a[44:47], v56, s[4:7], s39 offen offset:3072 nt
    s_mov_b32 exec_hi, 0
    s_add_u32 m0, s82, 87040
    s_add_u32 s39, s40, 1048576
    buffer_load_dwordx4 v58, s[28:31], s39 offen  lds
    s_mov_b64 exec, -1
    v_and_b32 v7, 15, v0
    s_mul_i32 s39, s3, 288
    v_and_b32 v2, 3, v0
    v_mul_u32_u24 v2, 1152, v2
    v_add_u32 v2, s39, v2
    v_lshrrev_b32 v57, 4, v0
    v_lshl_add_u32 v3, v57, 3, v2
    v_lshl_add_u32 v2, v57, 4, v2
    s_lshl_b32 s39, s3, 2
    s_add_u32 s39, s39, 158720
    v_lshl_add_u32 v7, v7, 4, s39
    v_bfe_u32 v57, v0, 2, 2
    v_lshl_add_u32 v2, v57, 6, v2
    v_mov_b32 v8, 0x3f803f80
    v_mov_b32 v9, 0x3f803f80
    v_mov_b32 v10, 0x3f803f80
    v_mov_b32 v11, 0x3f803f80
    v_mov_b32 v24, 0x3f803f80
    v_mov_b32 v25, 0x3f803f80
    v_bfe_u32 v4, v0, 2, 2
    s_mul_i32 s39, s3, 144
    v_add_u32 v4, s39, v4
    v_lshrrev_b32 v57, 4, v0
    v_lshl_add_u32 v5, v57, 2, v4
    v_lshl_add_u32 v4, v57, 3, v4
    v_and_b32 v57, 3, v0
    s_mov_b32 s39, 82944
    v_lshl_add_u32 v57, v57, 3, s39
    s_movk_i32 s39, 32
    v_mad_u32_u24 v4, v4, s39, v57
    v_mad_u32_u24 v5, v5, s39, v57
    v_and_b32 v30, 7, v0
    v_min_u32 v30, 4, v30
    v_lshrrev_b32 v28, 3, v0
    v_mul_u32_u24 v28, 128, v28
    v_lshl_add_u32 v28, v30, 4, v28
    v_lshrrev_b32 v27, 4, v0
    v_lshlrev_b32 v27, 1, v27
    v_lshl_add_u32 v30, v30, 3, v27
    s_mov_b32 s28, s48
    s_mov_b32 s29, s49
    s_mov_b32 s30, 2304
    s_mul_i32 s39, s33, 36
    s_and_b32 s40, s3, 1
    s_mul_i32 s40, s40, 1152
    s_add_u32 s39, s39, s40
    buffer_load_ushort v1, v30, s[28:31], s39 offen
    s_mov_b32 exec_lo, 0x33333333
    s_mov_b32 exec_hi, 0x33333333
    buffer_load_dwordx4 v[8:11], v2, s[28:31], 0 offen offset:0
    s_and_b32 exec_lo, exec_lo, 0xf000f
    s_and_b32 exec_hi, exec_hi, 0xf000f
    buffer_load_dwordx2 v[24:25], v3, s[28:31], 0 offen offset:256
    s_mov_b64 exec, -1
    v_mul_u32_u24 v58, 43, v0
    v_lshrrev_b32 v58, 7, v58
    v_mul_u32_u24 v59, 3, v58
    v_sub_u32 v59, v0, v59
    v_mul_u32_u24 v59, 12, v59
    s_mul_i32 s39, s3, 144
    v_add_u32 v57, s39, v58
    s_movk_i32 s39, 72
    v_mad_u32_u24 v240, v57, s39, v59
    s_movk_i32 s39, 1152
    v_mad_u32_u24 v241, v58, s39, v59
    s_movk_i32 s39, 9216
    v_mad_u32_u24 v242, v57, s39, v59
    s_add_u32 s39, s38, 49152
    buffer_load_dwordx4 a[48:51], v56, s[4:7], s39 offen offset:0 nt
    buffer_load_dwordx4 a[52:55], v56, s[4:7], s39 offen offset:1024 nt
    buffer_load_dwordx4 a[56:59], v56, s[4:7], s39 offen offset:2048 nt
    buffer_load_dwordx4 a[60:63], v56, s[4:7], s39 offen offset:3072 nt
    s_add_u32 s39, s38, 65536
    buffer_load_dwordx4 a[64:67], v56, s[4:7], s39 offen offset:0 nt
    buffer_load_dwordx4 a[68:71], v56, s[4:7], s39 offen offset:1024 nt
    buffer_load_dwordx4 a[72:75], v56, s[4:7], s39 offen offset:2048 nt
    buffer_load_dwordx4 a[76:79], v56, s[4:7], s39 offen offset:3072 nt
    s_add_u32 s39, s38, 81920
    buffer_load_dwordx4 a[80:83], v56, s[4:7], s39 offen offset:0 nt
    buffer_load_dwordx4 a[84:87], v56, s[4:7], s39 offen offset:1024 nt
    buffer_load_dwordx4 a[88:91], v56, s[4:7], s39 offen offset:2048 nt
    buffer_load_dwordx4 a[92:95], v56, s[4:7], s39 offen offset:3072 nt
    s_waitcnt vmcnt(12)
    v_lshlrev_b32 v1, 16, v1
    ds_read_b64_tr_b16 v[26:27], v4 offset:0
    ds_read_b64_tr_b16 v[28:29], v4 offset:128
    ds_read_b64_tr_b16 v[30:31], v4 offset:1024
    ds_read_b64_tr_b16 v[32:33], v4 offset:1152
    ds_read_b64_tr_b16 v[34:35], v4 offset:2048
    ds_read_b64_tr_b16 v[36:37], v4 offset:2176
    ds_read_b64_tr_b16 v[38:39], v4 offset:3072
    ds_read_b64_tr_b16 v[40:41], v4 offset:3200
    ds_read_b64_tr_b16 v[42:43], v5 offset:4096
    v_mfma_f32_16x16x16_bf16 v[52:55], v[24:25], v[24:25], 0
    v_mov_b32_dpp v12, v8 row_shl:4 row_mask:0xf bank_mask:0xf bound_ctrl:1
    v_mov_b32_dpp v13, v9 row_shl:4 row_mask:0xf bank_mask:0xf bound_ctrl:1
    v_mov_b32_dpp v14, v10 row_shl:4 row_mask:0xf bank_mask:0xf bound_ctrl:1
    v_mov_b32_dpp v15, v11 row_shl:4 row_mask:0xf bank_mask:0xf bound_ctrl:1
    s_nop 1
    v_mfma_f32_16x16x32_bf16 v[52:55], v[8:11], v[8:11], v[52:55]
    v_mov_b32_dpp v16, v8 row_shl:8 row_mask:0xf bank_mask:0xf bound_ctrl:1
    v_mov_b32_dpp v17, v9 row_shl:8 row_mask:0xf bank_mask:0xf bound_ctrl:1
    v_mov_b32_dpp v18, v10 row_shl:8 row_mask:0xf bank_mask:0xf bound_ctrl:1
    v_mov_b32_dpp v19, v11 row_shl:8 row_mask:0xf bank_mask:0xf bound_ctrl:1
    v_mfma_f32_16x16x32_bf16 v[52:55], v[12:15], v[12:15], v[52:55]
    v_mov_b32_dpp v20, v8 row_shl:12 row_mask:0xf bank_mask:0xf bound_ctrl:1
    v_mov_b32_dpp v21, v9 row_shl:12 row_mask:0xf bank_mask:0xf bound_ctrl:1
    v_mov_b32_dpp v22, v10 row_shl:12 row_mask:0xf bank_mask:0xf bound_ctrl:1
    v_mov_b32_dpp v23, v11 row_shl:12 row_mask:0xf bank_mask:0xf bound_ctrl:1
    v_mfma_f32_16x16x32_bf16 v[52:55], v[16:19], v[16:19], v[52:55]
    s_nop 0
    v_mfma_f32_16x16x32_bf16 v[52:55], v[20:23], v[20:23], v[52:55]
    s_waitcnt lgkmcnt(0)
    v_mfma_f32_16x16x32_bf16 v[44:47], v[8:11], v[26:29], 0
    v_mfma_f32_16x16x32_bf16 v[44:47], v[12:15], v[30:33], v[44:47]
    v_mfma_f32_16x16x32_bf16 v[44:47], v[16:19], v[34:37], v[44:47]
    v_mfma_f32_16x16x32_bf16 v[44:47], v[20:23], v[38:41], v[44:47]
    v_lshrrev_b32 v30, 1, v0
    v_and_b32 v31, 1, v0
    s_mov_b32 s39, 158720
    v_lshl_add_u32 v27, v30, 4, s39
    v_lshl_add_u32 v26, v31, 10, v27
    v_lshl_add_u32 v29, v31, 4, s39
    v_lshl_add_u32 v28, v31, 10, v29
    v_mul_u32_u24 v31, 576, v31
    v_add_lshl_u32 v30, v30, v31, 1
    v_mfma_f32_16x16x16_bf16 v[44:47], v[24:25], v[42:43], v[44:47]
    s_mov_b64 exec, 0xffff
    ds_write2st64_b32 v7, v52, v53 offset0:3 offset1:7
    ds_write_b32 v7, v54 offset:2816
    s_mov_b64 exec, -1
    s_mov_b64 exec, 0xffff
    s_nop 2
    ds_write2st64_b32 v7, v44, v45 offset0:0 offset1:4
    ds_write_b32 v7, v46 offset:2048
    s_mov_b64 exec, -1
    s_add_u32 s39, s38, 98304
    buffer_load_dwordx4 a[96:99], v56, s[4:7], s39 offen offset:0 nt
    buffer_load_dwordx4 a[100:103], v56, s[4:7], s39 offen offset:1024 nt
    buffer_load_dwordx4 a[104:107], v56, s[4:7], s39 offen offset:2048 nt
    buffer_load_dwordx4 a[108:111], v56, s[4:7], s39 offen offset:3072 nt
    s_mov_b32 s28, s56
    s_mov_b32 s29, s57
    s_mov_b32 s30, 4718592
    s_mul_i32 s85, s88, 36
    s_lshl_b32 s39, s32, 2
    s_add_u32 s39, s39, s3
    s_mul_i32 s39, s39, 147456
    s_add_u32 s85, s85, s39
    s_mov_b32 exec_lo, 0xffffffff
    s_mov_b32 exec_hi, 0x7fffffff
    s_add_u32 s39, s85, 0
    buffer_load_dwordx3 v[128:130], v241, s[28:31], s39 offen
    s_mov_b64 exec, -1
    s_mov_b32 exec_lo, 0xffffffff
    s_mov_b32 exec_hi, 0x7fffffff
    s_add_u32 s39, s85, 24192
    buffer_load_dwordx3 v[132:134], v241, s[28:31], s39 offen
    s_mov_b64 exec, -1
    s_lshl_b32 s46, s84, 9
    s_add_u32 s46, s46, 206848
    s_waitcnt lgkmcnt(0)
    s_barrier
    s_cmp_lg_u32 s3, 0
    s_cbranch_scc1 w0_1
    s_getreg_b32 s39, hwreg(HW_REG_XCC_ID, 0, 3)
    s_lshl_b32 s39, s39, 3
    s_lshl_b64 s[86:87], 1, s39
    s_lshl_b32 s39, s32, 5
    v_mov_b32 v59, s39
    v_mov_b32 v60, s86
    v_mov_b32 v61, s87
    s_mov_b64 exec, 1
    global_atomic_add_x2 v59, v[60:61], s[68:69] sc1
    s_mov_b32 exec_lo, -1
    ds_read_b128 v[36:39], v29 offset:2816
    ds_read_b128 v[32:35], v28 offset:768
    ds_read_b128 v[40:43], v26
    ds_read_b128 v[44:47], v27 offset:2048
    s_mov_b32 s82, 0x3ae38e39
    v_and_b32 v31, 1, v0
    v_lshrrev_b32 v30, 1, v0
    v_lshlrev_b32 v31, 7, v31
    v_add_lshl_u32 v30, v30, v31, 1
    s_waitcnt lgkmcnt(2)
    v_pk_add_f32 v[36:37], v[36:37], v[38:39]
    v_add_f32 v36, v36, v37
    v_pk_add_f32 v[32:33], v[32:33], v[34:35]
    v_add_f32 v32, v32, v33
    v_mul_f32 v36, 0xbae38e39, v36
    v_mul_f32 v33, v36, v36
    v_fma_f32 v32, v32, s82, -v33
    v_max_f32 v32, 0, v32
    v_add_f32 v32, 0x3727c5ac, v32
    v_rsq_f32 v32, v32
    s_waitcnt lgkmcnt(0)
    v_pk_add_f32 v[40:41], v[40:41], v[42:43]
    v_add_f32 v40, v40, v41
    v_pk_add_f32 v[44:45], v[44:45], v[46:47]
    v_add_f32 v44, v44, v45
    v_fma_f32 v40, v36, v44, v40
    v_mul_f32 v40, v40, v32
    s_nop 1
    v_mov_b32_dpp v41, v40 quad_perm:[2,3,2,3] row_mask:0xf bank_mask:0xf
    v_cvt_pk_bf16_f32 v40, v40, v41
w0_1:
    s_mov_b64 exec, -1
    s_add_u32 s39, s38, 114688
    buffer_load_dwordx4 a[112:115], v56, s[4:7], s39 offen offset:0 nt
    buffer_load_dwordx4 a[116:119], v56, s[4:7], s39 offen offset:1024 nt
    buffer_load_dwordx4 a[120:123], v56, s[4:7], s39 offen offset:2048 nt
    buffer_load_dwordx4 a[124:127], v56, s[4:7], s39 offen offset:3072 nt
    s_mov_b32 exec_lo, 0xffffffff
    s_mov_b32 exec_hi, 0x7fffffff
    s_add_u32 s39, s85, 48384
    buffer_load_dwordx3 v[136:138], v241, s[28:31], s39 offen
    s_mov_b64 exec, -1
    s_mov_b32 exec_lo, 0xffffffff
    s_mov_b32 exec_hi, 0x7fffffff
    s_add_u32 s39, s85, 72576
    buffer_load_dwordx3 v[140:142], v241, s[28:31], s39 offen
    s_mov_b64 exec, -1
    s_add_u32 s39, s38, 131072
    buffer_load_dwordx4 a[128:131], v56, s[4:7], s39 offen offset:0 nt
    buffer_load_dwordx4 a[132:135], v56, s[4:7], s39 offen offset:1024 nt
    buffer_load_dwordx4 a[136:139], v56, s[4:7], s39 offen offset:2048 nt
    buffer_load_dwordx4 a[140:143], v56, s[4:7], s39 offen offset:3072 nt
    s_mov_b32 exec_lo, 0xffffffff
    s_mov_b32 exec_hi, 0x7fffffff
    s_add_u32 s39, s85, 96768
    buffer_load_dwordx3 v[144:146], v241, s[28:31], s39 offen
    s_mov_b64 exec, -1
    s_add_u32 s39, s38, 147456
    buffer_load_dwordx4 a[144:147], v56, s[4:7], s39 offen offset:0 nt
    buffer_load_dwordx4 a[148:151], v56, s[4:7], s39 offen offset:1024 nt
    buffer_load_dwordx4 a[152:155], v56, s[4:7], s39 offen offset:2048 nt
    buffer_load_dwordx4 a[156:159], v56, s[4:7], s39 offen offset:3072 nt
    s_mov_b32 exec_lo, 0xffffffff
    s_mov_b32 exec_hi, 0x7fffffff
    s_add_u32 s39, s85, 120960
    buffer_load_dwordx3 v[148:150], v241, s[28:31], s39 offen
    s_mov_b64 exec, -1
    s_mov_b32 exec_lo, 0x3f
    s_mov_b32 exec_hi, 0x0
    s_add_u32 s39, s85, 145152
    buffer_load_dwordx3 v[152:154], v241, s[28:31], s39 offen
    s_mov_b64 exec, -1
    s_add_u32 s39, s38, 163840
    buffer_load_dwordx4 a[160:163], v56, s[4:7], s39 offen offset:0 nt
    buffer_load_dwordx4 a[164:167], v56, s[4:7], s39 offen offset:1024 nt
    buffer_load_dwordx4 a[168:171], v56, s[4:7], s39 offen offset:2048 nt
    buffer_load_dwordx4 a[172:175], v56, s[4:7], s39 offen offset:3072 nt
    s_mov_b32 s28, s60
    s_mov_b32 s29, s61
    s_mov_b32 s30, 5308416
    s_mul_i32 s85, s33, 36
    s_mul_i32 s39, s32, 1152
    s_add_u32 s85, s85, s39
    s_mov_b32 exec_lo, 0xffffffff
    s_mov_b32 exec_hi, 0x7fffffff
    s_add_u32 s39, s85, 0
    buffer_load_dwordx3 v[156:158], v242, s[28:31], s39 offen
    s_mov_b64 exec, -1
    s_mov_b32 exec_lo, 0xffffffff
    s_mov_b32 exec_hi, 0x7fffffff
    s_add_u32 s39, s85, 193536
    buffer_load_dwordx3 v[160:162], v242, s[28:31], s39 offen
    s_mov_b64 exec, -1
    s_add_u32 s39, s38, 180224
    buffer_load_dwordx4 a[176:179], v56, s[4:7], s39 offen offset:0 nt
    buffer_load_dwordx4 a[180:183], v56, s[4:7], s39 offen offset:1024 nt
    buffer_load_dwordx4 a[184:187], v56, s[4:7], s39 offen offset:2048 nt
    buffer_load_dwordx4 a[188:191], v56, s[4:7], s39 offen offset:3072 nt
    s_mov_b32 exec_lo, 0xffffffff
    s_mov_b32 exec_hi, 0x7fffffff
    s_add_u32 s39, s85, 387072
    buffer_load_dwordx3 v[164:166], v242, s[28:31], s39 offen
    s_mov_b64 exec, -1
    s_mov_b32 exec_lo, 0xffffffff
    s_mov_b32 exec_hi, 0x7fffffff
    s_add_u32 s39, s85, 580608
    buffer_load_dwordx3 v[168:170], v242, s[28:31], s39 offen
    s_mov_b64 exec, -1
    s_cmp_lg_u32 s3, 0
    s_cbranch_scc1 L_nogp
    v_and_b32 v59, 7, v0
    v_lshlrev_b32 v59, 5, v59
    global_load_dwordx2 v[60:61], v59, s[68:69] sc1
L_nogp:
    s_add_u32 s39, s38, 196608
    buffer_load_dwordx4 a[192:195], v56, s[4:7], s39 offen offset:0 nt
    buffer_load_dwordx4 a[196:199], v56, s[4:7], s39 offen offset:1024 nt
    buffer_load_dwordx4 a[200:203], v56, s[4:7], s39 offen offset:2048 nt
    buffer_load_dwordx4 a[204:207], v56, s[4:7], s39 offen offset:3072 nt
    s_mov_b32 exec_lo, 0xffffffff
    s_mov_b32 exec_hi, 0x7fffffff
    s_add_u32 s39, s85, 774144
    buffer_load_dwordx3 v[172:174], v242, s[28:31], s39 offen
    s_mov_b64 exec, -1
    s_add_u32 s39, s38, 212992
    buffer_load_dwordx4 a[208:211], v56, s[4:7], s39 offen offset:0 nt
    buffer_load_dwordx4 a[212:215], v56, s[4:7], s39 offen offset:1024 nt
    buffer_load_dwordx4 a[216:219], v56, s[4:7], s39 offen offset:2048 nt
    buffer_load_dwordx4 a[220:223], v56, s[4:7], s39 offen offset:3072 nt
    s_mov_b32 exec_lo, 0xffffffff
    s_mov_b32 exec_hi, 0x7fffffff
    s_add_u32 s39, s85, 967680
    buffer_load_dwordx3 v[176:178], v242, s[28:31], s39 offen
    s_mov_b64 exec, -1
    s_mov_b32 exec_lo, 0xffffffff
    s_mov_b32 exec_hi, 0x3fffff
    s_add_u32 s39, s85, 1161216
    buffer_load_dwordx3 v[180:182], v242, s[28:31], s39 offen
    s_mov_b64 exec, -1
    s_add_u32 s39, s38, 229376
    buffer_load_dwordx4 a[224:227], v56, s[4:7], s39 offen offset:0 nt
    buffer_load_dwordx4 a[228:231], v56, s[4:7], s39 offen offset:1024 nt
    buffer_load_dwordx4 a[232:235], v56, s[4:7], s39 offen offset:2048 nt
    buffer_load_dwordx4 a[236:239], v56, s[4:7], s39 offen offset:3072 nt
    s_mov_b32 s28, s62
    s_mov_b32 s29, s63
    s_mov_b32 s30, 5308416
    s_mul_i32 s85, s33, 36
    s_mul_i32 s39, s32, 1152
    s_add_u32 s85, s85, s39
    s_mov_b32 exec_lo, 0xffffffff
    s_mov_b32 exec_hi, 0x7fffffff
    s_add_u32 s39, s85, 0
    buffer_load_dwordx3 v[184:186], v242, s[28:31], s39 offen
    s_mov_b64 exec, -1
    s_mov_b32 exec_lo, 0xffffffff
    s_mov_b32 exec_hi, 0x7fffffff
    s_add_u32 s39, s85, 193536
    buffer_load_dwordx3 v[188:190], v242, s[28:31], s39 offen
    s_mov_b64 exec, -1
    s_cmp_lg_u32 s3, 0
    s_cbranch_scc1 L_q1p
    s_waitcnt vmcnt(17)
    s_branch L_gb_c
L_gb:
    global_load_dwordx2 v[60:61], v59, s[68:69] sc1
    s_add_u32 s41, s41, 1
    s_cmp_gt_u32 s41, 0x20000
    s_cbranch_scc1 L_end
    s_waitcnt vmcnt(0)
L_gb_c:
    v_sad_u8 v62, v60, 0, 0
    v_sad_u8 v62, v61, 0, v62
    v_cmp_ne_u32 vcc, 32, v62
    s_cbranch_vccnz L_gb
    v_or_b32 v62, v60, v61
    v_and_b32 v62, 0x20202020, v62
    v_cmp_eq_u32 vcc, 0, v62
    s_nop 4
    s_cmp_eq_u64 vcc, 0
    s_cselect_b32 s18, 0x20000000, 0
    s_cselect_b32 s22, 0, 0x20000000
    s_lshl_b32 s39, s35, 5
    s_add_u32 s39, s39, s46
    s_mov_b64 exec, 0x33333333
    buffer_store_dword v40, v30, s[16:19], s39 offen
    buffer_store_dword v40, v30, s[20:23], s39 offen sc1
    s_mov_b64 exec, -1
    v_mov_b32 v60, s18
    v_mov_b32 v61, 162880
    ds_write_b32 v61, v60
    v_and_b32 v61, 7, v0
    v_lshlrev_b32 v61, 7, v61
    v_lshrrev_b32 v60, 3, v0
    v_lshl_add_u32 v61, v60, 15, v61
    s_mul_i32 s39, s33, 1024
    s_add_u32 s39, s39, 223232
    buffer_load_dword v32, v61, s[12:15], s39 offen sc1
    s_waitcnt lgkmcnt(0)
L_q1p:
    s_add_u32 s39, s38, 245760
    buffer_load_dwordx4 a[240:243], v56, s[4:7], s39 offen offset:0 nt
    buffer_load_dwordx4 a[244:247], v56, s[4:7], s39 offen offset:1024 nt
    buffer_load_dwordx4 a[248:251], v56, s[4:7], s39 offen offset:2048 nt
    buffer_load_dwordx4 a[252:255], v56, s[4:7], s39 offen offset:3072 nt
    s_mov_b32 exec_lo, 0xffffffff
    s_mov_b32 exec_hi, 0x7fffffff
    s_add_u32 s39, s85, 387072
    buffer_load_dwordx3 v[192:194], v242, s[28:31], s39 offen
    s_mov_b64 exec, -1
    s_mov_b32 exec_lo, 0xffffffff
    s_mov_b32 exec_hi, 0x7fffffff
    s_add_u32 s39, s85, 580608
    buffer_load_dwordx3 v[196:198], v242, s[28:31], s39 offen
    s_mov_b64 exec, -1
    v_lshrrev_b32 v5, 4, v0
    v_and_b32 v7, 3, v0
    v_lshlrev_b32 v7, 4, v7
    v_lshl_add_u32 v5, v5, 6, v7
    v_lshl_add_u32 v3, v0, 4, s44
    s_add_u32 s39, s38, 0
    s_add_u32 m0, s45, 0
    s_nop 0
    buffer_load_dwordx4 v3, s[8:11], s39 offen offset:0 nt lds
    buffer_load_dwordx4 v3, s[8:11], s39 offen offset:1024 nt lds
    buffer_load_dwordx4 v3, s[8:11], s39 offen offset:2048 nt lds
    buffer_load_dwordx4 v3, s[8:11], s39 offen offset:3072 nt lds
    s_mov_b32 exec_lo, 0xffffffff
    s_mov_b32 exec_hi, 0x7fffffff
    s_add_u32 s39, s85, 774144
    buffer_load_dwordx3 v[200:202], v242, s[28:31], s39 offen
    s_mov_b64 exec, -1
    s_add_u32 s39, s38, 16384
    buffer_load_dwordx4 v[56:59], v3, s[8:11], s39 offen offset:0 nt
    buffer_load_dwordx4 v[60:63], v3, s[8:11], s39 offen offset:1024 nt
    buffer_load_dwordx4 v[64:67], v3, s[8:11], s39 offen offset:2048 nt
    buffer_load_dwordx4 v[68:71], v3, s[8:11], s39 offen offset:3072 nt
    s_mov_b32 exec_lo, 0xffffffff
    s_mov_b32 exec_hi, 0x7fffffff
    s_add_u32 s39, s85, 967680
    buffer_load_dwordx3 v[204:206], v242, s[28:31], s39 offen
    s_mov_b64 exec, -1
    s_mov_b32 exec_lo, 0xffffffff
    s_mov_b32 exec_hi, 0x3fffff
    s_add_u32 s39, s85, 1161216
    buffer_load_dwordx3 v[208:210], v242, s[28:31], s39 offen
    s_mov_b64 exec, -1
    s_add_u32 s39, s38, 32768
    s_add_u32 m0, s45, 4096
    s_nop 0
    buffer_load_dwordx4 v3, s[8:11], s39 offen offset:0 nt lds
    buffer_load_dwordx4 v3, s[8:11], s39 offen offset:1024 nt lds
    buffer_load_dwordx4 v3, s[8:11], s39 offen offset:2048 nt lds
    buffer_load_dwordx4 v3, s[8:11], s39 offen offset:3072 nt lds
    s_mov_b32 s28, s64
    s_mov_b32 s29, s65
    s_mov_b32 s30, 5308416
    s_mul_i32 s85, s89, 36
    s_lshl_b32 s39, s32, 2
    s_add_u32 s39, s39, s3
    s_mul_i32 s39, s39, 165888
    s_add_u32 s85, s85, s39
    s_mov_b32 exec_lo, 0xffffffff
    s_mov_b32 exec_hi, 0x7fffffff
    s_add_u32 s39, s85, 0
    buffer_load_dwordx3 v[212:214], v241, s[28:31], s39 offen
    s_mov_b64 exec, -1
    s_mov_b32 exec_lo, 0xffffffff
    s_mov_b32 exec_hi, 0x7fffffff
    s_add_u32 s39, s85, 24192
    buffer_load_dwordx3 v[216:218], v241, s[28:31], s39 offen
    s_mov_b64 exec, -1
    s_barrier
    v_mov_b32 v7, 162880
    ds_read_b32 v7, v7
    s_waitcnt lgkmcnt(0)
    v_readfirstlane_b32 s43, v7
    s_cmp_lg_u32 s43, 0
    s_cselect_b32 s18, 0x20000000, 0
    s_cselect_b32 s22, 0, 0x20000000
    buffer_load_dwordx4 v[24:27], v5, s[12:15], s46 offen sc1
    buffer_load_dwordx4 v[28:31], v5, s[12:15], s46 offen offset:256 sc1
    s_add_u32 s39, s38, 49152
    buffer_load_dwordx4 v[72:75], v3, s[8:11], s39 offen offset:0 nt
    buffer_load_dwordx4 v[76:79], v3, s[8:11], s39 offen offset:1024 nt
    buffer_load_dwordx4 v[80:83], v3, s[8:11], s39 offen offset:2048 nt
    buffer_load_dwordx4 v[84:87], v3, s[8:11], s39 offen offset:3072 nt
    s_mov_b32 exec_lo, 0xffffffff
    s_mov_b32 exec_hi, 0x7fffffff
    s_add_u32 s39, s85, 48384
    buffer_load_dwordx3 v[220:222], v241, s[28:31], s39 offen
    s_mov_b64 exec, -1
    s_mov_b32 exec_lo, 0xffffffff
    s_mov_b32 exec_hi, 0x7fffffff
    s_add_u32 s39, s85, 72576
    buffer_load_dwordx3 v[224:226], v241, s[28:31], s39 offen
    s_mov_b64 exec, -1
    s_add_u32 s39, s38, 65536
    s_add_u32 m0, s45, 8192
    s_nop 0
    buffer_load_dwordx4 v3, s[8:11], s39 offen offset:0 nt lds
    buffer_load_dwordx4 v3, s[8:11], s39 offen offset:1024 nt lds
    buffer_load_dwordx4 v3, s[8:11], s39 offen offset:2048 nt lds
    buffer_load_dwordx4 v3, s[8:11], s39 offen offset:3072 nt lds
    s_mov_b32 exec_lo, 0xffffffff
    s_mov_b32 exec_hi, 0x7fffffff
    s_add_u32 s39, s85, 96768
    buffer_load_dwordx3 v[228:230], v241, s[28:31], s39 offen
    s_mov_b64 exec, -1
    s_add_u32 s39, s38, 81920
    buffer_load_dwordx4 v[88:91], v3, s[8:11], s39 offen offset:0 nt
    buffer_load_dwordx4 v[92:95], v3, s[8:11], s39 offen offset:1024 nt
    buffer_load_dwordx4 v[96:99], v3, s[8:11], s39 offen offset:2048 nt
    buffer_load_dwordx4 v[100:103], v3, s[8:11], s39 offen offset:3072 nt
    s_mov_b32 exec_lo, 0xffffffff
    s_mov_b32 exec_hi, 0x7fffffff
    s_add_u32 s39, s85, 120960
    buffer_load_dwordx3 v[232:234], v241, s[28:31], s39 offen
    s_mov_b64 exec, -1
    s_mov_b32 exec_lo, 0xffffffff
    s_mov_b32 exec_hi, 0x3fffff
    s_add_u32 s39, s85, 145152
    buffer_load_dwordx3 v[236:238], v241, s[28:31], s39 offen
    s_mov_b64 exec, -1
    s_waitcnt vmcnt(17)
    s_branch L_q1_c
L_q1:
    buffer_load_dwordx4 v[24:27], v5, s[12:15], s46 offen sc1
    buffer_load_dwordx4 v[28:31], v5, s[12:15], s46 offen offset:256 sc1
    s_add_u32 s41, s41, 1
    s_cmp_gt_u32 s41, 0x20000
    s_cbranch_scc1 L_end
    s_waitcnt vmcnt(0)
L_q1_c:
    v_max3_u32 v7, v24, v25, v31
    v_max3_u32 v7, v7, v26, v27
    v_max3_u32 v7, v7, v28, v29
    v_max3_u32 v7, v7, v30, v31
    v_cmp_eq_u32 vcc, -1, v7
    s_cbranch_vccnz L_q1
    v_add_u32 v5, 163072, v5
    ds_write_b128 v5, v[28:31]
    s_add_u32 s39, s38, 98304
    s_add_u32 m0, s45, 12288
    s_nop 0
    buffer_load_dwordx4 v3, s[8:11], s39 offen offset:0 nt lds
    buffer_load_dwordx4 v3, s[8:11], s39 offen offset:1024 nt lds
    buffer_load_dwordx4 v[120:123], v3, s[8:11], s39 offen offset:2048 nt
    buffer_load_dwordx4 v[124:127], v3, s[8:11], s39 offen offset:3072 nt
    s_mov_b32 exec_lo, 0xffffffff
    s_mov_b32 exec_hi, 0x7fffffff
    ds_write_b32 v240, v128 offset:41472
    ds_write_b32 v240, v129 offset:41476
    ds_write_b32 v240, v130 offset:41480
    ds_write_b32 v240, v132 offset:42984
    ds_write_b32 v240, v133 offset:42988
    ds_write_b32 v240, v134 offset:42992
    ds_write_b32 v240, v136 offset:44496
    ds_write_b32 v240, v137 offset:44500
    ds_write_b32 v240, v138 offset:44504
    ds_write_b32 v240, v140 offset:46008
    ds_write_b32 v240, v141 offset:46012
    ds_write_b32 v240, v142 offset:46016
    ds_write_b32 v240, v144 offset:47520
    ds_write_b32 v240, v145 offset:47524
    ds_write_b32 v240, v146 offset:47528
    ds_write_b32 v240, v148 offset:49032
    ds_write_b32 v240, v149 offset:49036
    ds_write_b32 v240, v150 offset:49040
    s_mov_b32 exec_lo, 0x3f
    s_mov_b32 exec_hi, 0x0
    ds_write_b32 v240, v152 offset:50544
    ds_write_b32 v240, v153 offset:50548
    ds_write_b32 v240, v154 offset:50552
    s_mov_b32 exec_lo, 0xffffffff
    s_mov_b32 exec_hi, 0x7fffffff
    ds_write_b32 v240, v156 offset:0
    ds_write_b32 v240, v157 offset:4
    ds_write_b32 v240, v158 offset:8
    ds_write_b32 v240, v160 offset:1512
    ds_write_b32 v240, v161 offset:1516
    ds_write_b32 v240, v162 offset:1520
    ds_write_b32 v240, v164 offset:3024
    ds_write_b32 v240, v165 offset:3028
    ds_write_b32 v240, v166 offset:3032
    ds_write_b32 v240, v168 offset:4536
    ds_write_b32 v240, v169 offset:4540
    ds_write_b32 v240, v170 offset:4544
    ds_write_b32 v240, v172 offset:6048
    ds_write_b32 v240, v173 offset:6052
    ds_write_b32 v240, v174 offset:6056
    ds_write_b32 v240, v176 offset:7560
    ds_write_b32 v240, v177 offset:7564
    ds_write_b32 v240, v178 offset:7568
    s_mov_b32 exec_lo, 0xffffffff
    s_mov_b32 exec_hi, 0x3fffff
    ds_write_b32 v240, v180 offset:9072
    ds_write_b32 v240, v181 offset:9076
    ds_write_b32 v240, v182 offset:9080
    s_mov_b32 exec_lo, 0xffffffff
    s_mov_b32 exec_hi, 0x7fffffff
    ds_write_b32 v240, v184 offset:36
    ds_write_b32 v240, v185 offset:40
    ds_write_b32 v240, v186 offset:44
    ds_write_b32 v240, v188 offset:1548
    ds_write_b32 v240, v189 offset:1552
    ds_write_b32 v240, v190 offset:1556
    ds_write_b32 v240, v192 offset:3060
    ds_write_b32 v240, v193 offset:3064
    ds_write_b32 v240, v194 offset:3068
    ds_write_b32 v240, v196 offset:4572
    ds_write_b32 v240, v197 offset:4576
    ds_write_b32 v240, v198 offset:4580
    ds_write_b32 v240, v200 offset:6084
    ds_write_b32 v240, v201 offset:6088
    ds_write_b32 v240, v202 offset:6092
    ds_write_b32 v240, v204 offset:7596
    ds_write_b32 v240, v205 offset:7600
    ds_write_b32 v240, v206 offset:7604
    s_mov_b32 exec_lo, 0xffffffff
    s_mov_b32 exec_hi, 0x3fffff
    ds_write_b32 v240, v208 offset:9108
    ds_write_b32 v240, v209 offset:9112
    ds_write_b32 v240, v210 offset:9116
    s_mov_b32 exec_lo, 0xffffffff
    s_mov_b32 exec_hi, 0x7fffffff
    ds_write_b32 v240, v212 offset:41508
    ds_write_b32 v240, v213 offset:41512
    ds_write_b32 v240, v214 offset:41516
    ds_write_b32 v240, v216 offset:43020
    ds_write_b32 v240, v217 offset:43024
    ds_write_b32 v240, v218 offset:43028
    s_mov_b64 exec, -1
    s_add_u32 s39, s38, 114688
    buffer_load_dwordx4 v[104:107], v3, s[8:11], s39 offen offset:0 nt
    buffer_load_dwordx4 v[108:111], v3, s[8:11], s39 offen offset:1024 nt
    buffer_load_dwordx4 v[112:115], v3, s[8:11], s39 offen offset:2048 nt
    buffer_load_dwordx4 v[116:119], v3, s[8:11], s39 offen offset:3072 nt
    s_waitcnt vmcnt(8)
    s_mov_b32 exec_lo, 0xffffffff
    s_mov_b32 exec_hi, 0x7fffffff
    ds_write_b32 v240, v220 offset:44532
    ds_write_b32 v240, v221 offset:44536
    ds_write_b32 v240, v222 offset:44540
    ds_write_b32 v240, v224 offset:46044
    ds_write_b32 v240, v225 offset:46048
    ds_write_b32 v240, v226 offset:46052
    ds_write_b32 v240, v228 offset:47556
    ds_write_b32 v240, v229 offset:47560
    ds_write_b32 v240, v230 offset:47564
    ds_write_b32 v240, v232 offset:49068
    ds_write_b32 v240, v233 offset:49072
    ds_write_b32 v240, v234 offset:49076
    s_mov_b32 exec_lo, 0xffffffff
    s_mov_b32 exec_hi, 0x3fffff
    ds_write_b32 v240, v236 offset:50580
    ds_write_b32 v240, v237 offset:50584
    ds_write_b32 v240, v238 offset:50588
    s_mov_b64 exec, -1
    s_waitcnt lgkmcnt(0)
    s_mov_b32 s68, 0x22222222
    s_mov_b32 s69, 0x22222222
    s_mov_b32 s70, 0x44444444
    s_mov_b32 s71, 0x44444444
    s_mov_b32 s72, 0x88888888
    s_mov_b32 s73, 0x88888888
    s_mov_b32 s74, 0xf000f
    s_mov_b32 s75, 0xf000f
    s_mov_b32 s76, 0xf000f0
    s_mov_b32 s77, 0xf000f0
    s_mov_b32 s78, 0xf000f00
    s_mov_b32 s79, 0xf000f00
    s_mov_b32 s80, 0xf000f000
    s_mov_b32 s81, 0xf000f000
    s_mov_b32 s48, 0xff00ff
    s_mov_b32 s49, 0xff00ff
    s_mov_b32 s50, 0xffffffff
    s_mov_b32 s51, 0x0
    s_mov_b32 s52, 0x11111111
    s_mov_b32 s53, 0x11111111
    s_mov_b32 s54, 0x55555555
    s_mov_b32 s55, 0x55
    s_mov_b32 s56, 0x11111111
    s_mov_b32 s57, 0x1
    s_lshr_b32 s60, 1, s3
    s_and_b32 s60, s60, 1
    s_lshr_b32 s61, 1, s3
    s_and_b32 s61, s61, 1
    s_lshr_b32 s66, 0, s3
    s_and_b32 s66, s66, 1
    s_cmp_eq_u32 s32, s35
    s_cselect_b32 s66, s66, 0
    s_or_b32 s67, s66, s61
    s_mov_b32 s58, 0x11111111
    s_mov_b32 s59, 0x11111111
    s_mov_b32 s62, 0x55555555
    s_mov_b32 s63, 0x0
    s_mov_b32 s64, 0x11111111
    s_mov_b32 s65, 0x0
    s_mov_b32 s36, 0
    s_mov_b32 s42, 0
    s_lshl_b32 s90, s84, 8
    s_add_u32 s90, s90, s35
    s_lshl_b32 s90, s90, 4
    s_lshl_b32 s91, s84, 5
    s_add_u32 s91, s91, s35
    s_lshl_b32 s91, s91, 2
    s_add_u32 s91, s91, 202752
    s_lshl_b32 s39, s32, 2
    s_add_u32 s39, s39, s3
    s_lshl_b32 s92, s39, 12
    s_lshl_b32 s93, s39, 7
    s_add_u32 s93, s93, 202752
    s_and_b32 s40, s3, 1
    s_mul_i32 s39, s40, 65536
    s_mul_i32 s95, s33, 1024
    s_add_u32 s95, s95, s39
    s_add_u32 s95, s95, 223232
    s_add_u32 s97, s95, 32768
    s_mul_i32 s39, s32, 128
    s_mul_i32 s82, s3, 0
    s_add_u32 s39, s39, s82
    s_mul_i32 s94, s88, 1024
    s_add_u32 s94, s94, s39
    s_add_u32 s94, s94, 223232
    s_mul_i32 s96, s89, 1024
    s_add_u32 s96, s96, s39
    s_add_u32 s96, s96, 256000
    s_mul_i32 s85, s33, 36
    s_mul_i32 s39, s32, 2304
    s_add_u32 s98, s39, 131072
    s_add_u32 s100, s39, 149504
    s_add_u32 s28, s39, 167936
    s_add_u32 s101, s100, s85
    s_mul_i32 s40, s40, 1152
    s_add_u32 s85, s85, s40
    s_add_u32 s99, s98, s85
    s_add_u32 s29, s28, s85
    s_lshl_b32 s31, s84, 9
    s_add_u32 s31, s31, 186368
    s_lshl_b32 s39, s35, 5
    s_add_u32 s30, s31, s39
    v_bfe_u32 v2, v0, 2, 2
    v_lshl_add_u32 v2, v2, 8, s44
    v_lshrrev_b32 v7, 4, v0
    v_lshl_add_u32 v2, v7, 6, v2
    v_and_b32 v7, 3, v0
    v_lshl_add_u32 v2, v7, 4, v2
    v_lshl_add_u32 v3, v0, 4, s44
    v_lshl_add_u32 v4, v0, 4, s45
    v_and_b32 v7, 1, v0
    v_lshlrev_b32 v7, 4, v7
    s_mov_b32 s39, 0xffff
    v_lshlrev_b32 v7, v7, s39
    v_bfe_u32 v5, v0, 1, 2
    v_cmp_eq_u32 vcc, 0, v5
    s_nop 1
    v_cndmask_b32 v52, 0, v7, vcc
    v_cmp_eq_u32 vcc, 1, v5
    s_nop 1
    v_cndmask_b32 v53, 0, v7, vcc
    v_cmp_eq_u32 vcc, 2, v5
    s_nop 1
    v_cndmask_b32 v54, 0, v7, vcc
    v_cmp_eq_u32 vcc, 3, v5
    s_nop 1
    v_cndmask_b32 v55, 0, v7, vcc
L_attn:
    s_cmp_eq_u32 s42, 1
    s_cselect_b64 vcc, -1, 0
    v_cndmask_b32 v8, 0, v24, s[74:75]
    v_cndmask_b32 v9, 0, v25, s[74:75]
    v_cndmask_b32 v10, 0, v26, s[74:75]
    v_cndmask_b32 v11, 0, v27, s[74:75]
    v_cndmask_b32 v12, 0, v24, s[76:77]
    v_cndmask_b32 v13, 0, v25, s[76:77]
    v_cndmask_b32 v14, 0, v26, s[76:77]
    v_cndmask_b32 v15, 0, v27, s[76:77]
    s_waitcnt vmcnt(32)
    v_mfma_f32_16x16x32_bf16 v[28:31], a[0:3], v[8:11], 0
    v_cndmask_b32 v16, 0, v24, s[78:79]
    v_cndmask_b32 v17, 0, v25, s[78:79]
    v_cndmask_b32 v18, 0, v26, s[78:79]
    v_cndmask_b32 v19, 0, v27, s[78:79]
    v_mfma_f32_16x16x32_bf16 v[28:31], a[4:7], v[12:15], v[28:31]
    v_cndmask_b32 v20, 0, v24, s[80:81]
    v_cndmask_b32 v21, 0, v25, s[80:81]
    v_cndmask_b32 v22, 0, v26, s[80:81]
    v_cndmask_b32 v23, 0, v27, s[80:81]
    v_mfma_f32_16x16x32_bf16 v[28:31], a[8:11], v[16:19], v[28:31]
    s_nop 0
    v_mfma_f32_16x16x32_bf16 v[28:31], a[12:15], v[20:23], v[28:31]
    s_cbranch_vccnz hk_2_R
hk_2:
    v_mfma_f32_16x16x32_bf16 v[32:35], a[16:19], v[8:11], 0
    v_mfma_f32_16x16x32_bf16 v[32:35], a[20:23], v[12:15], v[32:35]
    v_mfma_f32_16x16x32_bf16 v[32:35], a[24:27], v[16:19], v[32:35]
    v_mfma_f32_16x16x32_bf16 v[32:35], a[28:31], v[20:23], v[32:35]
    s_cbranch_vccnz hk_3_R
    s_cmp_eq_u32 s42, 0
    s_cbranch_scc1 hk_3_S
hk_3:
    v_mfma_f32_16x16x32_bf16 v[36:39], a[32:35], v[8:11], 0
    v_add_f32_dpp v40, v29, v28 quad_perm:[1,1,1,1] row_mask:0xf bank_mask:0xf
    v_mfma_f32_16x16x32_bf16 v[36:39], a[36:39], v[12:15], v[36:39]
    s_nop 0
    v_add_f32_dpp v40, v30, v40 quad_perm:[2,2,2,2] row_mask:0xf bank_mask:0xf
    v_mfma_f32_16x16x32_bf16 v[36:39], a[40:43], v[16:19], v[36:39]
    s_nop 0
    v_add_f32_dpp v40, v31, v40 quad_perm:[3,3,3,3] row_mask:0xf bank_mask:0xf
    v_mfma_f32_16x16x32_bf16 v[36:39], a[44:47], v[20:23], v[36:39]
    v_mfma_f32_16x16x32_bf16 v[28:31], a[48:51], v[8:11], 0
    v_add_f32_dpp v44, v32, v33 quad_perm:[0,0,0,0] row_mask:0xf bank_mask:0xf
    v_mfma_f32_16x16x32_bf16 v[28:31], a[52:55], v[12:15], v[28:31]
    s_nop 0
    v_add_f32_dpp v44, v34, v44 quad_perm:[2,2,2,2] row_mask:0xf bank_mask:0xf
    v_mfma_f32_16x16x32_bf16 v[28:31], a[56:59], v[16:19], v[28:31]
    s_nop 0
    v_add_f32_dpp v44, v35, v44 quad_perm:[3,3,3,3] row_mask:0xf bank_mask:0xf
    v_mfma_f32_16x16x32_bf16 v[28:31], a[60:63], v[20:23], v[28:31]
    v_cndmask_b32 v40, v40, v44, s[68:69]
    s_cbranch_vccnz hk_4_R
    s_cmp_eq_u32 s42, 0
    s_cbranch_scc1 hk_4_S
hk_4:
    v_mfma_f32_16x16x32_bf16 v[32:35], a[64:67], v[8:11], 0
    v_add_f32_dpp v44, v36, v38 quad_perm:[0,0,0,0] row_mask:0xf bank_mask:0xf
    v_mfma_f32_16x16x32_bf16 v[32:35], a[68:71], v[12:15], v[32:35]
    s_nop 0
    v_add_f32_dpp v44, v37, v44 quad_perm:[1,1,1,1] row_mask:0xf bank_mask:0xf
    v_mfma_f32_16x16x32_bf16 v[32:35], a[72:75], v[16:19], v[32:35]
    s_nop 0
    v_add_f32_dpp v44, v39, v44 quad_perm:[3,3,3,3] row_mask:0xf bank_mask:0xf
    v_mfma_f32_16x16x32_bf16 v[32:35], a[76:79], v[20:23], v[32:35]
    v_cndmask_b32 v40, v40, v44, s[70:71]
    v_mfma_f32_16x16x32_bf16 v[36:39], a[80:83], v[8:11], 0
    v_add_f32_dpp v44, v28, v31 quad_perm:[0,0,0,0] row_mask:0xf bank_mask:0xf
    v_mfma_f32_16x16x32_bf16 v[36:39], a[84:87], v[12:15], v[36:39]
    s_nop 0
    v_add_f32_dpp v44, v29, v44 quad_perm:[1,1,1,1] row_mask:0xf bank_mask:0xf
    v_mfma_f32_16x16x32_bf16 v[36:39], a[88:91], v[16:19], v[36:39]
    s_nop 0
    v_add_f32_dpp v44, v30, v44 quad_perm:[2,2,2,2] row_mask:0xf bank_mask:0xf
    v_mfma_f32_16x16x32_bf16 v[36:39], a[92:95], v[20:23], v[36:39]
    v_cndmask_b32 v40, v40, v44, s[72:73]
    v_mfma_f32_16x16x32_bf16 v[28:31], a[96:99], v[8:11], 0
    v_add_f32_dpp v41, v33, v32 quad_perm:[1,1,1,1] row_mask:0xf bank_mask:0xf
    v_mfma_f32_16x16x32_bf16 v[28:31], a[100:103], v[12:15], v[28:31]
    s_nop 0
    v_add_f32_dpp v41, v34, v41 quad_perm:[2,2,2,2] row_mask:0xf bank_mask:0xf
    v_mfma_f32_16x16x32_bf16 v[28:31], a[104:107], v[16:19], v[28:31]
    s_nop 0
    v_add_f32_dpp v41, v35, v41 quad_perm:[3,3,3,3] row_mask:0xf bank_mask:0xf
    v_mfma_f32_16x16x32_bf16 v[28:31], a[108:111], v[20:23], v[28:31]
    v_mfma_f32_16x16x32_bf16 v[32:35], a[112:115], v[8:11], 0
    v_add_f32_dpp v44, v36, v37 quad_perm:[0,0,0,0] row_mask:0xf bank_mask:0xf
    v_mfma_f32_16x16x32_bf16 v[32:35], a[116:119], v[12:15], v[32:35]
    s_nop 0
    v_add_f32_dpp v44, v38, v44 quad_perm:[2,2,2,2] row_mask:0xf bank_mask:0xf
    v_mfma_f32_16x16x32_bf16 v[32:35], a[120:123], v[16:19], v[32:35]
    s_nop 0
    v_add_f32_dpp v44, v39, v44 quad_perm:[3,3,3,3] row_mask:0xf bank_mask:0xf
    v_mfma_f32_16x16x32_bf16 v[32:35], a[124:127], v[20:23], v[32:35]
    v_cndmask_b32 v41, v41, v44, s[68:69]
    s_cbranch_vccnz hk_5_R
    s_cmp_eq_u32 s42, 0
    s_cbranch_scc1 hk_5_S
hk_5:
    v_mfma_f32_16x16x32_bf16 v[36:39], a[128:131], v[8:11], 0
    v_add_f32_dpp v44, v28, v30 quad_perm:[0,0,0,0] row_mask:0xf bank_mask:0xf
    v_mfma_f32_16x16x32_bf16 v[36:39], a[132:135], v[12:15], v[36:39]
    s_nop 0
    v_add_f32_dpp v44, v29, v44 quad_perm:[1,1,1,1] row_mask:0xf bank_mask:0xf
    v_mfma_f32_16x16x32_bf16 v[36:39], a[136:139], v[16:19], v[36:39]
    s_nop 0
    v_add_f32_dpp v44, v31, v44 quad_perm:[3,3,3,3] row_mask:0xf bank_mask:0xf
    v_mfma_f32_16x16x32_bf16 v[36:39], a[140:143], v[20:23], v[36:39]
    v_cndmask_b32 v41, v41, v44, s[70:71]
    v_mfma_f32_16x16x32_bf16 v[28:31], a[144:147], v[8:11], 0
    v_add_f32_dpp v44, v32, v35 quad_perm:[0,0,0,0] row_mask:0xf bank_mask:0xf
    v_mfma_f32_16x16x32_bf16 v[28:31], a[148:151], v[12:15], v[28:31]
    s_nop 0
    v_add_f32_dpp v44, v33, v44 quad_perm:[1,1,1,1] row_mask:0xf bank_mask:0xf
    v_mfma_f32_16x16x32_bf16 v[28:31], a[152:155], v[16:19], v[28:31]
    s_nop 0
    v_add_f32_dpp v44, v34, v44 quad_perm:[2,2,2,2] row_mask:0xf bank_mask:0xf
    v_mfma_f32_16x16x32_bf16 v[28:31], a[156:159], v[20:23], v[28:31]
    v_cndmask_b32 v41, v41, v44, s[72:73]
    v_mfma_f32_16x16x32_bf16 v[32:35], a[160:163], v[8:11], 0
    v_add_f32_dpp v42, v37, v36 quad_perm:[1,1,1,1] row_mask:0xf bank_mask:0xf
    v_mfma_f32_16x16x32_bf16 v[32:35], a[164:167], v[12:15], v[32:35]
    s_nop 0
    v_add_f32_dpp v42, v38, v42 quad_perm:[2,2,2,2] row_mask:0xf bank_mask:0xf
    v_mfma_f32_16x16x32_bf16 v[32:35], a[168:171], v[16:19], v[32:35]
    s_nop 0
    v_add_f32_dpp v42, v39, v42 quad_perm:[3,3,3,3] row_mask:0xf bank_mask:0xf
    v_mfma_f32_16x16x32_bf16 v[32:35], a[172:175], v[20:23], v[32:35]
    v_mfma_f32_16x16x32_bf16 v[36:39], a[176:179], v[8:11], 0
    v_add_f32_dpp v44, v28, v29 quad_perm:[0,0,0,0] row_mask:0xf bank_mask:0xf
    v_mfma_f32_16x16x32_bf16 v[36:39], a[180:183], v[12:15], v[36:39]
    s_nop 0
    v_add_f32_dpp v44, v30, v44 quad_perm:[2,2,2,2] row_mask:0xf bank_mask:0xf
    v_mfma_f32_16x16x32_bf16 v[36:39], a[184:187], v[16:19], v[36:39]
    s_nop 0
    v_add_f32_dpp v44, v31, v44 quad_perm:[3,3,3,3] row_mask:0xf bank_mask:0xf
    v_mfma_f32_16x16x32_bf16 v[36:39], a[188:191], v[20:23], v[36:39]
    v_cndmask_b32 v42, v42, v44, s[68:69]
    s_cbranch_vccnz hk_6_R
    s_cmp_eq_u32 s42, 0
    s_cbranch_scc1 hk_6_S
hk_6:
    v_mfma_f32_16x16x32_bf16 v[28:31], a[192:195], v[8:11], 0
    v_add_f32_dpp v44, v32, v34 quad_perm:[0,0,0,0] row_mask:0xf bank_mask:0xf
    v_mfma_f32_16x16x32_bf16 v[28:31], a[196:199], v[12:15], v[28:31]
    s_nop 0
    v_add_f32_dpp v44, v33, v44 quad_perm:[1,1,1,1] row_mask:0xf bank_mask:0xf
    v_mfma_f32_16x16x32_bf16 v[28:31], a[200:203], v[16:19], v[28:31]
    s_nop 0
    v_add_f32_dpp v44, v35, v44 quad_perm:[3,3,3,3] row_mask:0xf bank_mask:0xf
    v_mfma_f32_16x16x32_bf16 v[28:31], a[204:207], v[20:23], v[28:31]
    v_cndmask_b32 v42, v42, v44, s[70:71]
    v_mfma_f32_16x16x32_bf16 v[32:35], a[208:211], v[8:11], 0
    v_add_f32_dpp v44, v36, v39 quad_perm:[0,0,0,0] row_mask:0xf bank_mask:0xf
    v_mfma_f32_16x16x32_bf16 v[32:35], a[212:215], v[12:15], v[32:35]
    s_nop 0
    v_add_f32_dpp v44, v37, v44 quad_perm:[1,1,1,1] row_mask:0xf bank_mask:0xf
    v_mfma_f32_16x16x32_bf16 v[32:35], a[216:219], v[16:19], v[32:35]
    s_nop 0
    v_add_f32_dpp v44, v38, v44 quad_perm:[2,2,2,2] row_mask:0xf bank_mask:0xf
    v_mfma_f32_16x16x32_bf16 v[32:35], a[220:223], v[20:23], v[32:35]
    v_cndmask_b32 v42, v42, v44, s[72:73]
    v_mfma_f32_16x16x32_bf16 v[36:39], a[224:227], v[8:11], 0
    v_add_f32_dpp v43, v29, v28 quad_perm:[1,1,1,1] row_mask:0xf bank_mask:0xf
    v_mfma_f32_16x16x32_bf16 v[36:39], a[228:231], v[12:15], v[36:39]
    s_nop 0
    v_add_f32_dpp v43, v30, v43 quad_perm:[2,2,2,2] row_mask:0xf bank_mask:0xf
    v_mfma_f32_16x16x32_bf16 v[36:39], a[232:235], v[16:19], v[36:39]
    s_nop 0
    v_add_f32_dpp v43, v31, v43 quad_perm:[3,3,3,3] row_mask:0xf bank_mask:0xf
    v_mfma_f32_16x16x32_bf16 v[36:39], a[236:239], v[20:23], v[36:39]
    v_mfma_f32_16x16x32_bf16 v[28:31], a[240:243], v[8:11], 0
    v_add_f32_dpp v44, v32, v33 quad_perm:[0,0,0,0] row_mask:0xf bank_mask:0xf
    v_mfma_f32_16x16x32_bf16 v[28:31], a[244:247], v[12:15], v[28:31]
    s_nop 0
    v_add_f32_dpp v44, v34, v44 quad_perm:[2,2,2,2] row_mask:0xf bank_mask:0xf
    v_mfma_f32_16x16x32_bf16 v[28:31], a[248:251], v[16:19], v[28:31]
    s_nop 0
    v_add_f32_dpp v44, v35, v44 quad_perm:[3,3,3,3] row_mask:0xf bank_mask:0xf
    v_mfma_f32_16x16x32_bf16 v[28:31], a[252:255], v[20:23], v[28:31]
    v_cndmask_b32 v43, v43, v44, s[68:69]
    s_cbranch_vccnz hk_7_R
    s_cmp_eq_u32 s42, 0
    s_cbranch_scc1 hk_7_S
hk_7:
    ds_read_b128 v[8:11], v4 offset:0
    ds_read_b128 v[12:15], v4 offset:1024
    ds_read_b128 v[16:19], v4 offset:2048
    ds_read_b128 v[20:23], v4 offset:3072
    v_add_f32_dpp v44, v36, v38 quad_perm:[0,0,0,0] row_mask:0xf bank_mask:0xf
    s_nop 1
    v_add_f32_dpp v44, v37, v44 quad_perm:[1,1,1,1] row_mask:0xf bank_mask:0xf
    s_nop 1
    v_add_f32_dpp v44, v39, v44 quad_perm:[3,3,3,3] row_mask:0xf bank_mask:0xf
    v_cndmask_b32 v43, v43, v44, s[70:71]
    s_nop 0
    v_add_f32_dpp v44, v28, v31 quad_perm:[0,0,0,0] row_mask:0xf bank_mask:0xf
    s_nop 1
    v_add_f32_dpp v44, v29, v44 quad_perm:[1,1,1,1] row_mask:0xf bank_mask:0xf
    s_nop 1
    v_add_f32_dpp v44, v30, v44 quad_perm:[2,2,2,2] row_mask:0xf bank_mask:0xf
    v_cndmask_b32 v43, v43, v44, s[72:73]
    v_max3_f32 v44, v40, v41, v42
    v_max_f32 v44, v44, v43
    v_mov_b32 v45, 0x3e0293ee
    s_nop 0
    v_max_f32_dpp v44, v44, v44 quad_perm:[1,0,3,2] row_mask:0xf bank_mask:0xf
    s_nop 1
    v_max_f32_dpp v44, v44, v44 quad_perm:[2,3,0,1] row_mask:0xf bank_mask:0xf
    s_nop 1
    v_max_f32_dpp v44, v44, v44 row_half_mirror row_mask:0xf bank_mask:0xf
    s_nop 1
    v_max_f32_dpp v44, v44, v44 row_mirror row_mask:0xf bank_mask:0xf
    s_nop 1
    v_max_f32_dpp v44, v44, v44 row_bcast:15 row_mask:0xa bank_mask:0xf
    s_nop 1
    v_max_f32_dpp v44, v44, v44 row_bcast:31 row_mask:0xc bank_mask:0xf
    v_mul_f32 v44, v45, v44
    s_nop 0
    v_readlane_b32 s82, v44, 63
    s_nop 1
    v_fma_f32 v40, v40, v45, -s82
    v_fma_f32 v41, v41, v45, -s82
    v_fma_f32 v42, v42, v45, -s82
    v_fma_f32 v43, v43, v45, -s82
    v_exp_f32 v40, v40
    v_exp_f32 v41, v41
    v_exp_f32 v42, v42
    v_exp_f32 v43, v43
    v_add_f32 v5, v40, v41
    v_add_f32 v7, v42, v43
    v_cvt_pk_bf16_f32 v40, v40, v40
    v_cvt_pk_bf16_f32 v41, v41, v41
    v_cvt_pk_bf16_f32 v42, v42, v42
    v_cvt_pk_bf16_f32 v43, v43, v43
    v_add_f32 v5, v5, v7
    v_mov_b32_dpp v36, v40 row_shr:4 row_mask:0xf bank_mask:0xf bound_ctrl:1
    v_mov_b32_dpp v37, v40 row_shl:4 row_mask:0xf bank_mask:0xf bound_ctrl:1
    v_and_b32_dpp v24, v40, v52 quad_perm:[0,0,0,0] row_mask:0xf bank_mask:0xf
    v_and_b32_dpp v25, v40, v53 quad_perm:[0,0,0,0] row_mask:0xf bank_mask:0xf
    v_and_b32_dpp v26, v36, v54 quad_perm:[0,0,0,0] row_mask:0xf bank_mask:0xf
    v_and_b32_dpp v27, v36, v55 quad_perm:[0,0,0,0] row_mask:0xf bank_mask:0xf
    v_and_b32_dpp v28, v37, v52 quad_perm:[0,0,0,0] row_mask:0xf bank_mask:0xf
    v_and_b32_dpp v29, v37, v53 quad_perm:[0,0,0,0] row_mask:0xf bank_mask:0xf
    v_and_b32_dpp v30, v40, v54 quad_perm:[0,0,0,0] row_mask:0xf bank_mask:0xf
    v_and_b32_dpp v31, v40, v55 quad_perm:[0,0,0,0] row_mask:0xf bank_mask:0xf
    s_waitcnt lgkmcnt(0)
    v_mfma_f32_16x16x32_bf16 v[44:47], v[8:11], v[24:27], 0
    v_and_b32_dpp v32, v40, v52 quad_perm:[1,1,1,1] row_mask:0xf bank_mask:0xf
    v_and_b32_dpp v33, v40, v53 quad_perm:[1,1,1,1] row_mask:0xf bank_mask:0xf
    v_mfma_f32_16x16x32_bf16 v[48:51], v[16:19], v[24:27], 0
    v_and_b32_dpp v34, v36, v54 quad_perm:[1,1,1,1] row_mask:0xf bank_mask:0xf
    v_and_b32_dpp v35, v36, v55 quad_perm:[1,1,1,1] row_mask:0xf bank_mask:0xf
    v_mfma_f32_16x16x32_bf16 v[44:47], v[12:15], v[28:31], v[44:47]
    v_and_b32_dpp v24, v37, v52 quad_perm:[1,1,1,1] row_mask:0xf bank_mask:0xf
    v_and_b32_dpp v25, v37, v53 quad_perm:[1,1,1,1] row_mask:0xf bank_mask:0xf
    v_mfma_f32_16x16x32_bf16 v[48:51], v[20:23], v[28:31], v[48:51]
    v_and_b32_dpp v26, v40, v54 quad_perm:[1,1,1,1] row_mask:0xf bank_mask:0xf
    v_and_b32_dpp v27, v40, v55 quad_perm:[1,1,1,1] row_mask:0xf bank_mask:0xf
    ds_read_b128 v[8:11], v4 offset:4096
    ds_read_b128 v[12:15], v4 offset:5120
    ds_read_b128 v[16:19], v4 offset:6144
    ds_read_b128 v[20:23], v4 offset:7168
    v_mfma_f32_16x16x32_bf16 v[44:47], v[56:59], v[32:35], v[44:47]
    v_and_b32_dpp v28, v40, v52 quad_perm:[2,2,2,2] row_mask:0xf bank_mask:0xf
    v_and_b32_dpp v29, v40, v53 quad_perm:[2,2,2,2] row_mask:0xf bank_mask:0xf
    v_mfma_f32_16x16x32_bf16 v[48:51], v[64:67], v[32:35], v[48:51]
    v_and_b32_dpp v30, v36, v54 quad_perm:[2,2,2,2] row_mask:0xf bank_mask:0xf
    v_and_b32_dpp v31, v36, v55 quad_perm:[2,2,2,2] row_mask:0xf bank_mask:0xf
    v_mfma_f32_16x16x32_bf16 v[44:47], v[60:63], v[24:27], v[44:47]
    v_and_b32_dpp v32, v37, v52 quad_perm:[2,2,2,2] row_mask:0xf bank_mask:0xf
    v_and_b32_dpp v33, v37, v53 quad_perm:[2,2,2,2] row_mask:0xf bank_mask:0xf
    v_mfma_f32_16x16x32_bf16 v[48:51], v[68:71], v[24:27], v[48:51]
    v_and_b32_dpp v34, v40, v54 quad_perm:[2,2,2,2] row_mask:0xf bank_mask:0xf
    v_and_b32_dpp v35, v40, v55 quad_perm:[2,2,2,2] row_mask:0xf bank_mask:0xf
    v_mov_b32_dpp v38, v41 row_shr:4 row_mask:0xf bank_mask:0xf bound_ctrl:1
    v_mov_b32_dpp v39, v41 row_shl:4 row_mask:0xf bank_mask:0xf bound_ctrl:1
    s_waitcnt lgkmcnt(0)
    v_mfma_f32_16x16x32_bf16 v[44:47], v[8:11], v[28:31], v[44:47]
    v_and_b32_dpp v24, v40, v52 quad_perm:[3,3,3,3] row_mask:0xf bank_mask:0xf
    v_and_b32_dpp v25, v40, v53 quad_perm:[3,3,3,3] row_mask:0xf bank_mask:0xf
    v_mfma_f32_16x16x32_bf16 v[48:51], v[16:19], v[28:31], v[48:51]
    v_and_b32_dpp v26, v36, v54 quad_perm:[3,3,3,3] row_mask:0xf bank_mask:0xf
    v_and_b32_dpp v27, v36, v55 quad_perm:[3,3,3,3] row_mask:0xf bank_mask:0xf
    v_mfma_f32_16x16x32_bf16 v[44:47], v[12:15], v[32:35], v[44:47]
    v_and_b32_dpp v28, v37, v52 quad_perm:[3,3,3,3] row_mask:0xf bank_mask:0xf
    v_and_b32_dpp v29, v37, v53 quad_perm:[3,3,3,3] row_mask:0xf bank_mask:0xf
    v_mfma_f32_16x16x32_bf16 v[48:51], v[20:23], v[32:35], v[48:51]
    v_and_b32_dpp v30, v40, v54 quad_perm:[3,3,3,3] row_mask:0xf bank_mask:0xf
    v_and_b32_dpp v31, v40, v55 quad_perm:[3,3,3,3] row_mask:0xf bank_mask:0xf
    ds_read_b128 v[8:11], v4 offset:8192
    ds_read_b128 v[12:15], v4 offset:9216
    ds_read_b128 v[16:19], v4 offset:10240
    ds_read_b128 v[20:23], v4 offset:11264
    v_mfma_f32_16x16x32_bf16 v[44:47], v[72:75], v[24:27], v[44:47]
    v_and_b32_dpp v32, v41, v52 quad_perm:[0,0,0,0] row_mask:0xf bank_mask:0xf
    v_and_b32_dpp v33, v41, v53 quad_perm:[0,0,0,0] row_mask:0xf bank_mask:0xf
    v_mfma_f32_16x16x32_bf16 v[48:51], v[80:83], v[24:27], v[48:51]
    v_and_b32_dpp v34, v38, v54 quad_perm:[0,0,0,0] row_mask:0xf bank_mask:0xf
    v_and_b32_dpp v35, v38, v55 quad_perm:[0,0,0,0] row_mask:0xf bank_mask:0xf
    v_mfma_f32_16x16x32_bf16 v[44:47], v[76:79], v[28:31], v[44:47]
    v_and_b32_dpp v24, v39, v52 quad_perm:[0,0,0,0] row_mask:0xf bank_mask:0xf
    v_and_b32_dpp v25, v39, v53 quad_perm:[0,0,0,0] row_mask:0xf bank_mask:0xf
    v_mfma_f32_16x16x32_bf16 v[48:51], v[84:87], v[28:31], v[48:51]
    v_and_b32_dpp v26, v41, v54 quad_perm:[0,0,0,0] row_mask:0xf bank_mask:0xf
    v_and_b32_dpp v27, v41, v55 quad_perm:[0,0,0,0] row_mask:0xf bank_mask:0xf
    s_cbranch_vccnz hk_8_R
hk_8:
    s_waitcnt lgkmcnt(0)
    v_mfma_f32_16x16x32_bf16 v[44:47], v[8:11], v[32:35], v[44:47]
    v_and_b32_dpp v28, v41, v52 quad_perm:[1,1,1,1] row_mask:0xf bank_mask:0xf
    v_and_b32_dpp v29, v41, v53 quad_perm:[1,1,1,1] row_mask:0xf bank_mask:0xf
    v_mfma_f32_16x16x32_bf16 v[48:51], v[16:19], v[32:35], v[48:51]
    v_and_b32_dpp v30, v38, v54 quad_perm:[1,1,1,1] row_mask:0xf bank_mask:0xf
    v_and_b32_dpp v31, v38, v55 quad_perm:[1,1,1,1] row_mask:0xf bank_mask:0xf
    v_add_f32_dpp v5, v5, v5 quad_perm:[1,0,3,2] row_mask:0xf bank_mask:0xf
    v_mfma_f32_16x16x32_bf16 v[44:47], v[12:15], v[24:27], v[44:47]
    v_and_b32_dpp v32, v39, v52 quad_perm:[1,1,1,1] row_mask:0xf bank_mask:0xf
    v_and_b32_dpp v33, v39, v53 quad_perm:[1,1,1,1] row_mask:0xf bank_mask:0xf
    v_mfma_f32_16x16x32_bf16 v[48:51], v[20:23], v[24:27], v[48:51]
    v_and_b32_dpp v34, v41, v54 quad_perm:[1,1,1,1] row_mask:0xf bank_mask:0xf
    v_and_b32_dpp v35, v41, v55 quad_perm:[1,1,1,1] row_mask:0xf bank_mask:0xf
    ds_read_b128 v[8:11], v4 offset:12288
    ds_read_b128 v[12:15], v4 offset:13312
    v_mfma_f32_16x16x32_bf16 v[44:47], v[88:91], v[28:31], v[44:47]
    v_and_b32_dpp v24, v41, v52 quad_perm:[2,2,2,2] row_mask:0xf bank_mask:0xf
    v_and_b32_dpp v25, v41, v53 quad_perm:[2,2,2,2] row_mask:0xf bank_mask:0xf
    v_mfma_f32_16x16x32_bf16 v[48:51], v[96:99], v[28:31], v[48:51]
    v_and_b32_dpp v26, v38, v54 quad_perm:[2,2,2,2] row_mask:0xf bank_mask:0xf
    v_and_b32_dpp v27, v38, v55 quad_perm:[2,2,2,2] row_mask:0xf bank_mask:0xf
    v_add_f32_dpp v5, v5, v5 quad_perm:[2,3,0,1] row_mask:0xf bank_mask:0xf
    v_mfma_f32_16x16x32_bf16 v[44:47], v[92:95], v[32:35], v[44:47]
    v_and_b32_dpp v28, v39, v52 quad_perm:[2,2,2,2] row_mask:0xf bank_mask:0xf
    v_and_b32_dpp v29, v39, v53 quad_perm:[2,2,2,2] row_mask:0xf bank_mask:0xf
    v_mfma_f32_16x16x32_bf16 v[48:51], v[100:103], v[32:35], v[48:51]
    v_and_b32_dpp v30, v41, v54 quad_perm:[2,2,2,2] row_mask:0xf bank_mask:0xf
    v_and_b32_dpp v31, v41, v55 quad_perm:[2,2,2,2] row_mask:0xf bank_mask:0xf
    v_mov_b32_dpp v36, v42 row_shr:4 row_mask:0xf bank_mask:0xf bound_ctrl:1
    v_mov_b32_dpp v37, v42 row_shl:4 row_mask:0xf bank_mask:0xf bound_ctrl:1
    s_waitcnt lgkmcnt(0)
    v_mfma_f32_16x16x32_bf16 v[44:47], v[8:11], v[24:27], v[44:47]
    v_and_b32_dpp v32, v41, v52 quad_perm:[3,3,3,3] row_mask:0xf bank_mask:0xf
    v_and_b32_dpp v33, v41, v53 quad_perm:[3,3,3,3] row_mask:0xf bank_mask:0xf
    v_mfma_f32_16x16x32_bf16 v[48:51], v[120:123], v[24:27], v[48:51]
    v_and_b32_dpp v34, v38, v54 quad_perm:[3,3,3,3] row_mask:0xf bank_mask:0xf
    v_and_b32_dpp v35, v38, v55 quad_perm:[3,3,3,3] row_mask:0xf bank_mask:0xf
    v_add_f32_dpp v5, v5, v5 row_half_mirror row_mask:0xf bank_mask:0xf
    v_mfma_f32_16x16x32_bf16 v[44:47], v[12:15], v[28:31], v[44:47]
    v_and_b32_dpp v24, v39, v52 quad_perm:[3,3,3,3] row_mask:0xf bank_mask:0xf
    v_and_b32_dpp v25, v39, v53 quad_perm:[3,3,3,3] row_mask:0xf bank_mask:0xf
    v_mfma_f32_16x16x32_bf16 v[48:51], v[124:127], v[28:31], v[48:51]
    v_and_b32_dpp v26, v41, v54 quad_perm:[3,3,3,3] row_mask:0xf bank_mask:0xf
    v_and_b32_dpp v27, v41, v55 quad_perm:[3,3,3,3] row_mask:0xf bank_mask:0xf
    v_mfma_f32_16x16x32_bf16 v[44:47], v[104:107], v[32:35], v[44:47]
    v_and_b32_dpp v28, v42, v52 quad_perm:[0,0,0,0] row_mask:0xf bank_mask:0xf
    v_and_b32_dpp v29, v42, v53 quad_perm:[0,0,0,0] row_mask:0xf bank_mask:0xf
    v_mfma_f32_16x16x32_bf16 v[48:51], v[112:115], v[32:35], v[48:51]
    v_and_b32_dpp v30, v36, v54 quad_perm:[0,0,0,0] row_mask:0xf bank_mask:0xf
    v_and_b32_dpp v31, v36, v55 quad_perm:[0,0,0,0] row_mask:0xf bank_mask:0xf
    v_add_f32_dpp v5, v5, v5 row_mirror row_mask:0xf bank_mask:0xf
    v_mfma_f32_16x16x32_bf16 v[44:47], v[108:111], v[24:27], v[44:47]
    v_and_b32_dpp v32, v37, v52 quad_perm:[0,0,0,0] row_mask:0xf bank_mask:0xf
    v_and_b32_dpp v33, v37, v53 quad_perm:[0,0,0,0] row_mask:0xf bank_mask:0xf
    v_mfma_f32_16x16x32_bf16 v[48:51], v[116:119], v[24:27], v[48:51]
    v_and_b32_dpp v34, v42, v54 quad_perm:[0,0,0,0] row_mask:0xf bank_mask:0xf
    v_and_b32_dpp v35, v42, v55 quad_perm:[0,0,0,0] row_mask:0xf bank_mask:0xf
    s_cbranch_vccnz hk_9_R
hk_9:
    s_cbranch_vccnz sw_10
    s_waitcnt vmcnt(24)
sw_10:
    v_mfma_f32_16x16x32_bf16 v[44:47], v[128:131], v[28:31], v[44:47]
    v_and_b32_dpp v24, v42, v52 quad_perm:[1,1,1,1] row_mask:0xf bank_mask:0xf
    v_and_b32_dpp v25, v42, v53 quad_perm:[1,1,1,1] row_mask:0xf bank_mask:0xf
    v_mfma_f32_16x16x32_bf16 v[48:51], v[136:139], v[28:31], v[48:51]
    v_and_b32_dpp v26, v36, v54 quad_perm:[1,1,1,1] row_mask:0xf bank_mask:0xf
    v_and_b32_dpp v27, v36, v55 quad_perm:[1,1,1,1] row_mask:0xf bank_mask:0xf
    v_add_f32_dpp v5, v5, v5 row_bcast:15 row_mask:0xa bank_mask:0xf
    v_mfma_f32_16x16x32_bf16 v[44:47], v[132:135], v[32:35], v[44:47]
    v_and_b32_dpp v28, v37, v52 quad_perm:[1,1,1,1] row_mask:0xf bank_mask:0xf
    v_and_b32_dpp v29, v37, v53 quad_perm:[1,1,1,1] row_mask:0xf bank_mask:0xf
    v_mfma_f32_16x16x32_bf16 v[48:51], v[140:143], v[32:35], v[48:51]
    v_and_b32_dpp v30, v42, v54 quad_perm:[1,1,1,1] row_mask:0xf bank_mask:0xf
    v_and_b32_dpp v31, v42, v55 quad_perm:[1,1,1,1] row_mask:0xf bank_mask:0xf
    v_mfma_f32_16x16x32_bf16 v[44:47], v[144:147], v[24:27], v[44:47]
    v_and_b32_dpp v32, v42, v52 quad_perm:[2,2,2,2] row_mask:0xf bank_mask:0xf
    v_and_b32_dpp v33, v42, v53 quad_perm:[2,2,2,2] row_mask:0xf bank_mask:0xf
    v_mfma_f32_16x16x32_bf16 v[48:51], v[152:155], v[24:27], v[48:51]
    v_and_b32_dpp v34, v36, v54 quad_perm:[2,2,2,2] row_mask:0xf bank_mask:0xf
    v_and_b32_dpp v35, v36, v55 quad_perm:[2,2,2,2] row_mask:0xf bank_mask:0xf
    v_add_f32_dpp v5, v5, v5 row_bcast:31 row_mask:0xc bank_mask:0xf
    s_lshl_b32 s39, s3, 2
    s_add_u32 s39, s39, 162816
    v_mov_b32 v16, s39
    v_mov_b32 v17, s82
    s_mov_b32 exec_lo, 0
    s_mov_b32 exec_hi, 0x80000000
    ds_write2_b32 v16, v17, v5 offset0:0 offset1:4
    s_mov_b64 exec, -1
    v_mov_b32 v16, 162816
    v_mfma_f32_16x16x32_bf16 v[44:47], v[148:151], v[28:31], v[44:47]
    v_and_b32_dpp v24, v37, v52 quad_perm:[2,2,2,2] row_mask:0xf bank_mask:0xf
    v_and_b32_dpp v25, v37, v53 quad_perm:[2,2,2,2] row_mask:0xf bank_mask:0xf
    v_mfma_f32_16x16x32_bf16 v[48:51], v[156:159], v[28:31], v[48:51]
    v_and_b32_dpp v26, v42, v54 quad_perm:[2,2,2,2] row_mask:0xf bank_mask:0xf
    v_and_b32_dpp v27, v42, v55 quad_perm:[2,2,2,2] row_mask:0xf bank_mask:0xf
    v_mov_b32_dpp v38, v43 row_shr:4 row_mask:0xf bank_mask:0xf bound_ctrl:1
    v_mov_b32_dpp v39, v43 row_shl:4 row_mask:0xf bank_mask:0xf bound_ctrl:1
    s_cbranch_vccnz sw_11
    s_waitcnt vmcnt(16)
sw_11:
    v_mfma_f32_16x16x32_bf16 v[44:47], v[160:163], v[32:35], v[44:47]
    v_and_b32_dpp v28, v42, v52 quad_perm:[3,3,3,3] row_mask:0xf bank_mask:0xf
    v_and_b32_dpp v29, v42, v53 quad_perm:[3,3,3,3] row_mask:0xf bank_mask:0xf
    v_mfma_f32_16x16x32_bf16 v[48:51], v[168:171], v[32:35], v[48:51]
    v_and_b32_dpp v30, v36, v54 quad_perm:[3,3,3,3] row_mask:0xf bank_mask:0xf
    v_and_b32_dpp v31, v36, v55 quad_perm:[3,3,3,3] row_mask:0xf bank_mask:0xf
    s_waitcnt lgkmcnt(0)
    s_barrier
    ds_read_b128 v[8:11], v16
    ds_read_b128 v[12:15], v16 offset:16
    v_mfma_f32_16x16x32_bf16 v[44:47], v[164:167], v[24:27], v[44:47]
    v_and_b32_dpp v32, v37, v52 quad_perm:[3,3,3,3] row_mask:0xf bank_mask:0xf
    v_and_b32_dpp v33, v37, v53 quad_perm:[3,3,3,3] row_mask:0xf bank_mask:0xf
    v_mfma_f32_16x16x32_bf16 v[48:51], v[172:175], v[24:27], v[48:51]
    v_and_b32_dpp v34, v42, v54 quad_perm:[3,3,3,3] row_mask:0xf bank_mask:0xf
    v_and_b32_dpp v35, v42, v55 quad_perm:[3,3,3,3] row_mask:0xf bank_mask:0xf
    v_mfma_f32_16x16x32_bf16 v[44:47], v[176:179], v[28:31], v[44:47]
    v_and_b32_dpp v24, v43, v52 quad_perm:[0,0,0,0] row_mask:0xf bank_mask:0xf
    v_and_b32_dpp v25, v43, v53 quad_perm:[0,0,0,0] row_mask:0xf bank_mask:0xf
    v_mfma_f32_16x16x32_bf16 v[48:51], v[184:187], v[28:31], v[48:51]
    v_and_b32_dpp v26, v38, v54 quad_perm:[0,0,0,0] row_mask:0xf bank_mask:0xf
    v_and_b32_dpp v27, v38, v55 quad_perm:[0,0,0,0] row_mask:0xf bank_mask:0xf
    s_waitcnt lgkmcnt(0)
    v_max3_f32 v18, v8, v9, v10
    v_max_f32 v18, v18, v11
    v_mfma_f32_16x16x32_bf16 v[44:47], v[180:183], v[32:35], v[44:47]
    v_and_b32_dpp v28, v39, v52 quad_perm:[0,0,0,0] row_mask:0xf bank_mask:0xf
    v_and_b32_dpp v29, v39, v53 quad_perm:[0,0,0,0] row_mask:0xf bank_mask:0xf
    v_mfma_f32_16x16x32_bf16 v[48:51], v[188:191], v[32:35], v[48:51]
    v_and_b32_dpp v30, v43, v54 quad_perm:[0,0,0,0] row_mask:0xf bank_mask:0xf
    v_and_b32_dpp v31, v43, v55 quad_perm:[0,0,0,0] row_mask:0xf bank_mask:0xf
    v_sub_f32 v8, v8, v18
    v_sub_f32 v9, v9, v18
    v_sub_f32 v10, v10, v18
    v_sub_f32 v11, v11, v18
    v_sub_f32 v17, v17, v18
    s_cbranch_vccnz sw_12
    s_waitcnt vmcnt(8)
sw_12:
    v_mfma_f32_16x16x32_bf16 v[44:47], v[192:195], v[24:27], v[44:47]
    v_and_b32_dpp v32, v43, v52 quad_perm:[1,1,1,1] row_mask:0xf bank_mask:0xf
    v_and_b32_dpp v33, v43, v53 quad_perm:[1,1,1,1] row_mask:0xf bank_mask:0xf
    v_mfma_f32_16x16x32_bf16 v[48:51], v[200:203], v[24:27], v[48:51]
    v_and_b32_dpp v34, v38, v54 quad_perm:[1,1,1,1] row_mask:0xf bank_mask:0xf
    v_and_b32_dpp v35, v38, v55 quad_perm:[1,1,1,1] row_mask:0xf bank_mask:0xf
    v_exp_f32 v8, v8
    v_exp_f32 v9, v9
    v_exp_f32 v10, v10
    v_exp_f32 v11, v11
    v_exp_f32 v17, v17
    v_mfma_f32_16x16x32_bf16 v[44:47], v[196:199], v[28:31], v[44:47]
    v_and_b32_dpp v24, v39, v52 quad_perm:[1,1,1,1] row_mask:0xf bank_mask:0xf
    v_and_b32_dpp v25, v39, v53 quad_perm:[1,1,1,1] row_mask:0xf bank_mask:0xf
    v_mfma_f32_16x16x32_bf16 v[48:51], v[204:207], v[28:31], v[48:51]
    v_and_b32_dpp v26, v43, v54 quad_perm:[1,1,1,1] row_mask:0xf bank_mask:0xf
    v_and_b32_dpp v27, v43, v55 quad_perm:[1,1,1,1] row_mask:0xf bank_mask:0xf
    v_mul_f32 v12, v8, v12
    v_fmac_f32 v12, v9, v13
    v_fmac_f32 v12, v10, v14
    v_fmac_f32 v12, v11, v15
    v_rcp_f32 v13, v12
    v_mfma_f32_16x16x32_bf16 v[44:47], v[208:211], v[32:35], v[44:47]
    v_and_b32_dpp v28, v43, v52 quad_perm:[2,2,2,2] row_mask:0xf bank_mask:0xf
    v_and_b32_dpp v29, v43, v53 quad_perm:[2,2,2,2] row_mask:0xf bank_mask:0xf
    v_mfma_f32_16x16x32_bf16 v[48:51], v[216:219], v[32:35], v[48:51]
    v_and_b32_dpp v30, v38, v54 quad_perm:[2,2,2,2] row_mask:0xf bank_mask:0xf
    v_and_b32_dpp v31, v38, v55 quad_perm:[2,2,2,2] row_mask:0xf bank_mask:0xf
    v_mul_f32 v16, v17, v13
    v_log_f32 v14, v12
    v_mfma_f32_16x16x32_bf16 v[44:47], v[212:215], v[24:27], v[44:47]
    v_and_b32_dpp v32, v39, v52 quad_perm:[2,2,2,2] row_mask:0xf bank_mask:0xf
    v_and_b32_dpp v33, v39, v53 quad_perm:[2,2,2,2] row_mask:0xf bank_mask:0xf
    v_mfma_f32_16x16x32_bf16 v[48:51], v[220:223], v[24:27], v[48:51]
    v_and_b32_dpp v34, v43, v54 quad_perm:[2,2,2,2] row_mask:0xf bank_mask:0xf
    v_and_b32_dpp v35, v43, v55 quad_perm:[2,2,2,2] row_mask:0xf bank_mask:0xf
    s_cbranch_vccnz sw_13
    s_waitcnt vmcnt(4)
sw_13:
    v_mfma_f32_16x16x32_bf16 v[44:47], v[224:227], v[28:31], v[44:47]
    v_and_b32_dpp v24, v43, v52 quad_perm:[3,3,3,3] row_mask:0xf bank_mask:0xf
    v_and_b32_dpp v25, v43, v53 quad_perm:[3,3,3,3] row_mask:0xf bank_mask:0xf
    v_mfma_f32_16x16x32_bf16 v[48:51], v[232:235], v[28:31], v[48:51]
    v_and_b32_dpp v26, v38, v54 quad_perm:[3,3,3,3] row_mask:0xf bank_mask:0xf
    v_and_b32_dpp v27, v38, v55 quad_perm:[3,3,3,3] row_mask:0xf bank_mask:0xf
    v_mfma_f32_16x16x32_bf16 v[44:47], v[228:231], v[32:35], v[44:47]
    v_and_b32_dpp v28, v39, v52 quad_perm:[3,3,3,3] row_mask:0xf bank_mask:0xf
    v_and_b32_dpp v29, v39, v53 quad_perm:[3,3,3,3] row_mask:0xf bank_mask:0xf
    v_mfma_f32_16x16x32_bf16 v[48:51], v[236:239], v[32:35], v[48:51]
    v_and_b32_dpp v30, v43, v54 quad_perm:[3,3,3,3] row_mask:0xf bank_mask:0xf
    v_and_b32_dpp v31, v43, v55 quad_perm:[3,3,3,3] row_mask:0xf bank_mask:0xf
    s_cbranch_vccnz sw_14
    s_waitcnt vmcnt(0)
sw_14:
    v_mfma_f32_16x16x32_bf16 v[44:47], v[240:243], v[24:27], v[44:47]
    v_lshrrev_b32 v20, 4, v0
    v_and_b32 v21, 7, v0
    v_lshl_add_u32 v20, v20, 3, v21
    s_lshl_b32 s39, s3, 9
    s_add_u32 s39, s39, 158720
    v_mfma_f32_16x16x32_bf16 v[48:51], v[248:251], v[24:27], v[48:51]
    v_lshl_add_u32 v20, v20, 4, s39
    v_add_f32 v14, v14, v18
    v_mfma_f32_16x16x32_bf16 v[44:47], v[244:247], v[28:31], v[44:47]
    s_mov_b32 s39, 158720
    v_lshl_add_u32 v24, v0, 3, s39
    v_and_b32 v26, 3, v0
    v_lshlrev_b32 v26, 2, v26
    v_mfma_f32_16x16x32_bf16 v[48:51], v[252:255], v[28:31], v[48:51]
    v_lshrrev_b32 v27, 2, v0
    v_lshl_add_u32 v26, v27, 8, v26
    s_nop 5
    v_add_f32_dpp v44, v48, v44 row_ror:8 row_mask:0xf bank_mask:0xf
    v_add_f32_dpp v45, v49, v45 row_ror:8 row_mask:0xf bank_mask:0xf
    v_add_f32_dpp v46, v50, v46 row_ror:8 row_mask:0xf bank_mask:0xf
    v_add_f32_dpp v47, v51, v47 row_ror:8 row_mask:0xf bank_mask:0xf
    s_mov_b32 exec_lo, 0x00ff00ff
    s_mov_b32 exec_hi, 0x00ff00ff
    v_pk_mul_f32 v[44:45], v[44:45], v[16:17] op_sel_hi:[1,0]
    v_pk_mul_f32 v[46:47], v[46:47], v[16:17] op_sel_hi:[1,0]
    ds_write_b128 v20, v[44:47]
    s_mov_b64 exec, -1
    s_waitcnt lgkmcnt(0)
    s_barrier
    s_cmp_lg_u32 s3, 0
    s_cbranch_scc1 w0_15
    ds_read_b64 v[16:17], v24 offset:0
    ds_read_b64 v[18:19], v24 offset:512
    ds_read_b64 v[20:21], v24 offset:1024
    ds_read_b64 v[22:23], v24 offset:1536
    s_mov_b64 exec, 1
    buffer_store_dword v14, v26, s[16:19], s91 offen
    buffer_store_dword v14, v26, s[20:23], s91 offen sc1
    s_mov_b64 exec, -1
    v_and_b32 v5, 15, v0
    v_lshrrev_b32 v7, 4, v0
    v_lshl_add_u32 v3, v7, 2, v0
    v_and_b32 v3, 7, v3
    v_and_b32 v2, 32, v0
    v_lshl_add_u32 v3, v3, 2, v2
    v_lshlrev_b32 v2, 4, v0
    s_lshl_b32 s39, s3, 2
    s_add_u32 s39, s39, 158720
    v_lshl_add_u32 v5, v5, 4, s39
    v_lshl_add_u32 v5, v7, 9, v5
    v_bfe_u32 v4, v0, 2, 2
    v_lshl_add_u32 v4, v4, 2, v7
    s_mul_i32 s39, s3, 72
    v_add_u32 v4, s39, v4
    v_and_b32 v7, 3, v0
    v_lshlrev_b32 v7, 3, v7
    s_movk_i32 s39, 144
    v_mad_u32_u24 v4, v4, s39, v7
    s_waitcnt lgkmcnt(2)
    v_pk_add_f32 v[16:17], v[16:17], v[18:19]
    s_waitcnt lgkmcnt(0)
    v_pk_add_f32 v[20:21], v[20:21], v[22:23]
    v_pk_add_f32 v[16:17], v[16:17], v[20:21]
    v_cvt_pk_bf16_f32 v16, v16, v17
    buffer_store_dword v16, v26, s[16:19], s90 offen
    buffer_store_dword v16, v26, s[20:23], s90 offen sc1
    s_branch w0_15_j
w0_15:
    v_and_b32 v5, 15, v0
    v_lshrrev_b32 v7, 4, v0
    v_lshl_add_u32 v3, v7, 2, v0
    v_and_b32 v3, 7, v3
    v_and_b32 v2, 32, v0
    v_lshl_add_u32 v3, v3, 2, v2
    v_lshlrev_b32 v2, 4, v0
    s_lshl_b32 s39, s3, 2
    s_add_u32 s39, s39, 158720
    v_lshl_add_u32 v5, v5, 4, s39
    v_lshl_add_u32 v5, v7, 9, v5
    v_bfe_u32 v4, v0, 2, 2
    v_lshl_add_u32 v4, v4, 2, v7
    s_mul_i32 s39, s3, 72
    v_add_u32 v4, s39, v4
    v_and_b32 v7, 3, v0
    v_lshlrev_b32 v7, 3, v7
    s_movk_i32 s39, 144
    v_mad_u32_u24 v4, v4, s39, v7
w0_15_j:
    s_mov_b64 exec, -1
    s_barrier
    s_cbranch_vccz L_mid
    v_bfe_u32 v2, v0, 2, 2
    v_lshl_add_u32 v2, v2, 8, s44
    v_lshrrev_b32 v7, 4, v0
    v_lshl_add_u32 v2, v7, 6, v2
    v_and_b32 v7, 3, v0
    v_lshl_add_u32 v2, v7, 4, v2
    v_lshl_add_u32 v3, v0, 4, s44
    v_lshl_add_u32 v4, v0, 4, s45
    v_and_b32 v7, 1, v0
    v_lshlrev_b32 v7, 4, v7
    s_mov_b32 s39, 0xffff
    v_lshlrev_b32 v7, v7, s39
    v_bfe_u32 v5, v0, 1, 2
    v_cmp_eq_u32 vcc, 0, v5
    s_nop 1
    v_cndmask_b32 v52, 0, v7, vcc
    v_cmp_eq_u32 vcc, 1, v5
    s_nop 1
    v_cndmask_b32 v53, 0, v7, vcc
    v_cmp_eq_u32 vcc, 2, v5
    s_nop 1
    v_cndmask_b32 v54, 0, v7, vcc
    v_cmp_eq_u32 vcc, 3, v5
    s_nop 1
    v_cndmask_b32 v55, 0, v7, vcc
    v_lshrrev_b32 v5, 4, v0
    v_and_b32 v7, 3, v0
    v_lshlrev_b32 v7, 4, v7
    v_lshl_add_u32 v5, v5, 6, v7
    v_add_u32 v5, 163072, v5
    ds_read_b128 v[24:27], v5
    s_mov_b32 s42, 0
    s_add_u32 s90, s90, 128
    s_add_u32 s91, s91, 32
    s_waitcnt lgkmcnt(0)
    s_branch L_attn
hk_2_R:
    s_add_u32 s39, s38, 0
    buffer_load_dwordx4 a[0:3], v2, s[4:7], s39 offen offset:0 nt
    buffer_load_dwordx4 a[4:7], v2, s[4:7], s39 offen offset:1024 nt
    buffer_load_dwordx4 a[8:11], v2, s[4:7], s39 offen offset:2048 nt
    buffer_load_dwordx4 a[12:15], v2, s[4:7], s39 offen offset:3072 nt
    s_branch hk_2
hk_3_R:
    s_add_u32 s39, s38, 16384
    buffer_load_dwordx4 a[16:19], v2, s[4:7], s39 offen offset:0 nt
    buffer_load_dwordx4 a[20:23], v2, s[4:7], s39 offen offset:1024 nt
    buffer_load_dwordx4 a[24:27], v2, s[4:7], s39 offen offset:2048 nt
    buffer_load_dwordx4 a[28:31], v2, s[4:7], s39 offen offset:3072 nt
    s_branch hk_3
hk_3_S:
    s_add_u32 s39, s38, 131072
    buffer_load_dwordx4 v[128:131], v3, s[8:11], s39 offen offset:0 nt
    buffer_load_dwordx4 v[132:135], v3, s[8:11], s39 offen offset:1024 nt
    buffer_load_dwordx4 v[136:139], v3, s[8:11], s39 offen offset:2048 nt
    buffer_load_dwordx4 v[140:143], v3, s[8:11], s39 offen offset:3072 nt
    s_branch hk_3
hk_4_R:
    s_add_u32 s39, s38, 32768
    buffer_load_dwordx4 a[32:35], v2, s[4:7], s39 offen offset:0 nt
    buffer_load_dwordx4 a[36:39], v2, s[4:7], s39 offen offset:1024 nt
    buffer_load_dwordx4 a[40:43], v2, s[4:7], s39 offen offset:2048 nt
    buffer_load_dwordx4 a[44:47], v2, s[4:7], s39 offen offset:3072 nt
    s_add_u32 s39, s38, 49152
    buffer_load_dwordx4 a[48:51], v2, s[4:7], s39 offen offset:0 nt
    buffer_load_dwordx4 a[52:55], v2, s[4:7], s39 offen offset:1024 nt
    buffer_load_dwordx4 a[56:59], v2, s[4:7], s39 offen offset:2048 nt
    buffer_load_dwordx4 a[60:63], v2, s[4:7], s39 offen offset:3072 nt
    s_branch hk_4
hk_4_S:
    s_add_u32 s39, s38, 147456
    buffer_load_dwordx4 v[144:147], v3, s[8:11], s39 offen offset:0 nt
    buffer_load_dwordx4 v[148:151], v3, s[8:11], s39 offen offset:1024 nt
    buffer_load_dwordx4 v[152:155], v3, s[8:11], s39 offen offset:2048 nt
    buffer_load_dwordx4 v[156:159], v3, s[8:11], s39 offen offset:3072 nt
    s_branch hk_4
hk_5_R:
    s_add_u32 s39, s38, 65536
    buffer_load_dwordx4 a[64:67], v2, s[4:7], s39 offen offset:0 nt
    buffer_load_dwordx4 a[68:71], v2, s[4:7], s39 offen offset:1024 nt
    buffer_load_dwordx4 a[72:75], v2, s[4:7], s39 offen offset:2048 nt
    buffer_load_dwordx4 a[76:79], v2, s[4:7], s39 offen offset:3072 nt
    s_add_u32 s39, s38, 81920
    buffer_load_dwordx4 a[80:83], v2, s[4:7], s39 offen offset:0 nt
    buffer_load_dwordx4 a[84:87], v2, s[4:7], s39 offen offset:1024 nt
    buffer_load_dwordx4 a[88:91], v2, s[4:7], s39 offen offset:2048 nt
    buffer_load_dwordx4 a[92:95], v2, s[4:7], s39 offen offset:3072 nt
    s_add_u32 s39, s38, 98304
    buffer_load_dwordx4 a[96:99], v2, s[4:7], s39 offen offset:0 nt
    buffer_load_dwordx4 a[100:103], v2, s[4:7], s39 offen offset:1024 nt
    buffer_load_dwordx4 a[104:107], v2, s[4:7], s39 offen offset:2048 nt
    buffer_load_dwordx4 a[108:111], v2, s[4:7], s39 offen offset:3072 nt
    s_add_u32 s39, s38, 114688
    buffer_load_dwordx4 a[112:115], v2, s[4:7], s39 offen offset:0 nt
    buffer_load_dwordx4 a[116:119], v2, s[4:7], s39 offen offset:1024 nt
    buffer_load_dwordx4 a[120:123], v2, s[4:7], s39 offen offset:2048 nt
    buffer_load_dwordx4 a[124:127], v2, s[4:7], s39 offen offset:3072 nt
    s_branch hk_5
hk_5_S:
    s_add_u32 s39, s38, 163840
    buffer_load_dwordx4 v[160:163], v3, s[8:11], s39 offen offset:0 nt
    buffer_load_dwordx4 v[164:167], v3, s[8:11], s39 offen offset:1024 nt
    buffer_load_dwordx4 v[168:171], v3, s[8:11], s39 offen offset:2048 nt
    buffer_load_dwordx4 v[172:175], v3, s[8:11], s39 offen offset:3072 nt
    s_add_u32 s39, s38, 180224
    buffer_load_dwordx4 v[176:179], v3, s[8:11], s39 offen offset:0 nt
    buffer_load_dwordx4 v[180:183], v3, s[8:11], s39 offen offset:1024 nt
    buffer_load_dwordx4 v[184:187], v3, s[8:11], s39 offen offset:2048 nt
    buffer_load_dwordx4 v[188:191], v3, s[8:11], s39 offen offset:3072 nt
    s_branch hk_5
hk_6_R:
    s_add_u32 s39, s38, 131072
    buffer_load_dwordx4 a[128:131], v2, s[4:7], s39 offen offset:0 nt
    buffer_load_dwordx4 a[132:135], v2, s[4:7], s39 offen offset:1024 nt
    buffer_load_dwordx4 a[136:139], v2, s[4:7], s39 offen offset:2048 nt
    buffer_load_dwordx4 a[140:143], v2, s[4:7], s39 offen offset:3072 nt
    s_add_u32 s39, s38, 147456
    buffer_load_dwordx4 a[144:147], v2, s[4:7], s39 offen offset:0 nt
    buffer_load_dwordx4 a[148:151], v2, s[4:7], s39 offen offset:1024 nt
    buffer_load_dwordx4 a[152:155], v2, s[4:7], s39 offen offset:2048 nt
    buffer_load_dwordx4 a[156:159], v2, s[4:7], s39 offen offset:3072 nt
    s_add_u32 s39, s38, 163840
    buffer_load_dwordx4 a[160:163], v2, s[4:7], s39 offen offset:0 nt
    buffer_load_dwordx4 a[164:167], v2, s[4:7], s39 offen offset:1024 nt
    buffer_load_dwordx4 a[168:171], v2, s[4:7], s39 offen offset:2048 nt
    buffer_load_dwordx4 a[172:175], v2, s[4:7], s39 offen offset:3072 nt
    s_add_u32 s39, s38, 180224
    buffer_load_dwordx4 a[176:179], v2, s[4:7], s39 offen offset:0 nt
    buffer_load_dwordx4 a[180:183], v2, s[4:7], s39 offen offset:1024 nt
    buffer_load_dwordx4 a[184:187], v2, s[4:7], s39 offen offset:2048 nt
    buffer_load_dwordx4 a[188:191], v2, s[4:7], s39 offen offset:3072 nt
    s_branch hk_6
hk_6_S:
    s_add_u32 s39, s38, 196608
    buffer_load_dwordx4 v[192:195], v3, s[8:11], s39 offen offset:0 nt
    buffer_load_dwordx4 v[196:199], v3, s[8:11], s39 offen offset:1024 nt
    buffer_load_dwordx4 v[200:203], v3, s[8:11], s39 offen offset:2048 nt
    buffer_load_dwordx4 v[204:207], v3, s[8:11], s39 offen offset:3072 nt
    s_add_u32 s39, s38, 212992
    buffer_load_dwordx4 v[208:211], v3, s[8:11], s39 offen offset:0 nt
    buffer_load_dwordx4 v[212:215], v3, s[8:11], s39 offen offset:1024 nt
    buffer_load_dwordx4 v[216:219], v3, s[8:11], s39 offen offset:2048 nt
    buffer_load_dwordx4 v[220:223], v3, s[8:11], s39 offen offset:3072 nt
    s_branch hk_6
hk_7_R:
    s_add_u32 s39, s38, 196608
    buffer_load_dwordx4 a[192:195], v2, s[4:7], s39 offen offset:0 nt
    buffer_load_dwordx4 a[196:199], v2, s[4:7], s39 offen offset:1024 nt
    buffer_load_dwordx4 a[200:203], v2, s[4:7], s39 offen offset:2048 nt
    buffer_load_dwordx4 a[204:207], v2, s[4:7], s39 offen offset:3072 nt
    s_add_u32 s39, s38, 212992
    buffer_load_dwordx4 a[208:211], v2, s[4:7], s39 offen offset:0 nt
    buffer_load_dwordx4 a[212:215], v2, s[4:7], s39 offen offset:1024 nt
    buffer_load_dwordx4 a[216:219], v2, s[4:7], s39 offen offset:2048 nt
    buffer_load_dwordx4 a[220:223], v2, s[4:7], s39 offen offset:3072 nt
    s_add_u32 s39, s38, 229376
    buffer_load_dwordx4 a[224:227], v2, s[4:7], s39 offen offset:0 nt
    buffer_load_dwordx4 a[228:231], v2, s[4:7], s39 offen offset:1024 nt
    buffer_load_dwordx4 a[232:235], v2, s[4:7], s39 offen offset:2048 nt
    buffer_load_dwordx4 a[236:239], v2, s[4:7], s39 offen offset:3072 nt
    s_add_u32 s39, s38, 245760
    buffer_load_dwordx4 a[240:243], v2, s[4:7], s39 offen offset:0 nt
    buffer_load_dwordx4 a[244:247], v2, s[4:7], s39 offen offset:1024 nt
    buffer_load_dwordx4 a[248:251], v2, s[4:7], s39 offen offset:2048 nt
    buffer_load_dwordx4 a[252:255], v2, s[4:7], s39 offen offset:3072 nt
    s_branch hk_7
hk_7_S:
    s_add_u32 s39, s38, 229376
    buffer_load_dwordx4 v[224:227], v3, s[8:11], s39 offen offset:0 nt
    buffer_load_dwordx4 v[228:231], v3, s[8:11], s39 offen offset:1024 nt
    buffer_load_dwordx4 v[232:235], v3, s[8:11], s39 offen offset:2048 nt
    buffer_load_dwordx4 v[236:239], v3, s[8:11], s39 offen offset:3072 nt
    s_add_u32 s39, s38, 245760
    buffer_load_dwordx4 v[240:243], v3, s[8:11], s39 offen offset:0 nt
    buffer_load_dwordx4 v[244:247], v3, s[8:11], s39 offen offset:1024 nt
    buffer_load_dwordx4 v[248:251], v3, s[8:11], s39 offen offset:2048 nt
    buffer_load_dwordx4 v[252:255], v3, s[8:11], s39 offen offset:3072 nt
    s_waitcnt vmcnt(32)
    s_branch hk_7
hk_8_R:
    s_add_u32 s39, s38, 0
    s_add_u32 m0, s45, 0
    s_nop 0
    buffer_load_dwordx4 v3, s[8:11], s39 offen offset:0 nt lds
    buffer_load_dwordx4 v3, s[8:11], s39 offen offset:1024 nt lds
    buffer_load_dwordx4 v3, s[8:11], s39 offen offset:2048 nt lds
    buffer_load_dwordx4 v3, s[8:11], s39 offen offset:3072 nt lds
    s_add_u32 s39, s38, 16384
    buffer_load_dwordx4 v[56:59], v3, s[8:11], s39 offen offset:0 nt
    buffer_load_dwordx4 v[60:63], v3, s[8:11], s39 offen offset:1024 nt
    buffer_load_dwordx4 v[64:67], v3, s[8:11], s39 offen offset:2048 nt
    buffer_load_dwordx4 v[68:71], v3, s[8:11], s39 offen offset:3072 nt
    s_add_u32 s39, s38, 32768
    s_add_u32 m0, s45, 4096
    s_nop 0
    buffer_load_dwordx4 v3, s[8:11], s39 offen offset:0 nt lds
    buffer_load_dwordx4 v3, s[8:11], s39 offen offset:1024 nt lds
    buffer_load_dwordx4 v3, s[8:11], s39 offen offset:2048 nt lds
    buffer_load_dwordx4 v3, s[8:11], s39 offen offset:3072 nt lds
    s_add_u32 s39, s38, 49152
    buffer_load_dwordx4 v[72:75], v3, s[8:11], s39 offen offset:0 nt
    buffer_load_dwordx4 v[76:79], v3, s[8:11], s39 offen offset:1024 nt
    buffer_load_dwordx4 v[80:83], v3, s[8:11], s39 offen offset:2048 nt
    buffer_load_dwordx4 v[84:87], v3, s[8:11], s39 offen offset:3072 nt
    s_branch hk_8
hk_9_R:
    s_add_u32 s39, s38, 65536
    s_add_u32 m0, s45, 8192
    s_nop 0
    buffer_load_dwordx4 v3, s[8:11], s39 offen offset:0 nt lds
    buffer_load_dwordx4 v3, s[8:11], s39 offen offset:1024 nt lds
    buffer_load_dwordx4 v3, s[8:11], s39 offen offset:2048 nt lds
    buffer_load_dwordx4 v3, s[8:11], s39 offen offset:3072 nt lds
    s_add_u32 s39, s38, 81920
    buffer_load_dwordx4 v[88:91], v3, s[8:11], s39 offen offset:0 nt
    buffer_load_dwordx4 v[92:95], v3, s[8:11], s39 offen offset:1024 nt
    buffer_load_dwordx4 v[96:99], v3, s[8:11], s39 offen offset:2048 nt
    buffer_load_dwordx4 v[100:103], v3, s[8:11], s39 offen offset:3072 nt
    s_add_u32 s39, s38, 98304
    s_add_u32 m0, s45, 12288
    s_nop 0
    buffer_load_dwordx4 v3, s[8:11], s39 offen offset:0 nt lds
    buffer_load_dwordx4 v3, s[8:11], s39 offen offset:1024 nt lds
    buffer_load_dwordx4 v[120:123], v3, s[8:11], s39 offen offset:2048 nt
    buffer_load_dwordx4 v[124:127], v3, s[8:11], s39 offen offset:3072 nt
    s_add_u32 s39, s38, 114688
    buffer_load_dwordx4 v[104:107], v3, s[8:11], s39 offen offset:0 nt
    buffer_load_dwordx4 v[108:111], v3, s[8:11], s39 offen offset:1024 nt
    buffer_load_dwordx4 v[112:115], v3, s[8:11], s39 offen offset:2048 nt
    buffer_load_dwordx4 v[116:119], v3, s[8:11], s39 offen offset:3072 nt
    s_branch hk_9
L_mid:
    s_mov_b64 exec, s[50:51]
    buffer_load_dword v7, v3, s[12:15], s93 offen sc1
    s_mov_b64 exec, s[48:49]
    buffer_load_dwordx4 v[8:11], v2, s[12:15], s92 offen offset:0 sc1
    buffer_load_dwordx4 v[12:15], v2, s[12:15], s92 offen offset:1024 sc1
    buffer_load_dwordx4 v[16:19], v2, s[12:15], s92 offen offset:2048 sc1
    buffer_load_dwordx4 v[20:23], v2, s[12:15], s92 offen offset:3072 sc1
    s_mov_b64 exec, -1
    ds_read_b64_tr_b16 v[24:25], v4 offset:41472
    ds_read_b64_tr_b16 v[26:27], v4 offset:41544
    ds_read_b64_tr_b16 v[28:29], v4 offset:43776
    ds_read_b64_tr_b16 v[30:31], v4 offset:43848
    ds_read_b64_tr_b16 v[32:33], v4 offset:46080
    ds_read_b64_tr_b16 v[34:35], v4 offset:46152
    ds_read_b64_tr_b16 v[36:37], v4 offset:48384
    ds_read_b64_tr_b16 v[38:39], v4 offset:48456
    ds_read_b64_tr_b16 v[40:41], v4 offset:41504
    ds_read_b64_tr_b16 v[42:43], v4 offset:41576
    ds_read_b64_tr_b16 v[44:45], v4 offset:43808
    ds_read_b64_tr_b16 v[46:47], v4 offset:43880
    s_branch L_wp_w
L_wp:
    s_mov_b64 exec, s[50:51]
    buffer_load_dword v7, v3, s[12:15], s93 offen sc1
    s_mov_b64 exec, s[48:49]
    buffer_load_dwordx4 v[8:11], v2, s[12:15], s92 offen offset:0 sc1
    buffer_load_dwordx4 v[12:15], v2, s[12:15], s92 offen offset:1024 sc1
    buffer_load_dwordx4 v[16:19], v2, s[12:15], s92 offen offset:2048 sc1
    buffer_load_dwordx4 v[20:23], v2, s[12:15], s92 offen offset:3072 sc1
    s_mov_b64 exec, -1
    s_add_u32 s41, s41, 1
    s_cmp_gt_u32 s41, 0x20000
    s_cbranch_scc1 L_end
L_wp_w:
    s_waitcnt vmcnt(0) lgkmcnt(0)
    v_mfma_f32_16x16x32_bf16 v[48:51], v[8:11], v[24:27], 0
    v_max3_u32 v52, v8, v9, v23
    v_max3_u32 v52, v52, v10, v11
    v_mfma_f32_16x16x32_bf16 v[48:51], v[12:15], v[28:31], v[48:51]
    v_max3_u32 v52, v52, v12, v13
    v_max3_u32 v52, v52, v14, v15
    v_mfma_f32_16x16x32_bf16 v[48:51], v[16:19], v[32:35], v[48:51]
    v_max3_u32 v52, v52, v16, v17
    v_max3_u32 v52, v52, v18, v19
    v_mfma_f32_16x16x32_bf16 v[48:51], v[20:23], v[36:39], v[48:51]
    v_max3_u32 v52, v52, v20, v21
    v_max3_u32 v52, v52, v22, v23
    v_cmp_eq_u32 s[86:87], -1, v7
    v_cmp_eq_u32 vcc, -1, v52
    s_and_b64 s[86:87], s[86:87], s[50:51]
    s_and_b64 vcc, vcc, s[48:49]
    s_or_b64 vcc, vcc, s[86:87]
    s_cbranch_scc1 L_wp
    ds_read_b64_tr_b16 v[24:25], v4 offset:46112
    ds_read_b64_tr_b16 v[26:27], v4 offset:46184
    ds_read_b64_tr_b16 v[28:29], v4 offset:48416
    ds_read_b64_tr_b16 v[30:31], v4 offset:48488
    v_max_f32_dpp v3, v7, v7 quad_perm:[1,0,3,2] row_mask:0xf bank_mask:0xf
    v_mfma_f32_16x16x32_bf16 v[52:55], v[8:11], v[40:43], 0
    s_nop 0
    v_max_f32_dpp v3, v3, v3 quad_perm:[2,3,0,1] row_mask:0xf bank_mask:0xf
    v_mfma_f32_16x16x32_bf16 v[52:55], v[12:15], v[44:47], v[52:55]
    s_nop 0
    v_max_f32_dpp v3, v3, v3 row_half_mirror row_mask:0xf bank_mask:0xf
    v_sub_f32 v7, v7, v3
    v_exp_f32 v7, v7
    s_waitcnt lgkmcnt(2)
    v_mfma_f32_16x16x32_bf16 v[52:55], v[16:19], v[24:27], v[52:55]
    v_add_f32_dpp v3, v7, v7 quad_perm:[1,0,3,2] row_mask:0xf bank_mask:0xf
    s_waitcnt lgkmcnt(0)
    v_mfma_f32_16x16x32_bf16 v[52:55], v[20:23], v[28:31], v[52:55]
    v_add_f32_dpp v3, v3, v3 quad_perm:[2,3,0,1] row_mask:0xf bank_mask:0xf
    v_mul_f32_dpp v48, v7, v48 row_newbcast:0 row_mask:0xf bank_mask:0xf
    s_nop 0
    v_add_f32_dpp v3, v3, v3 row_half_mirror row_mask:0xf bank_mask:0xf
    v_fmac_f32_dpp v48, v7, v49 row_newbcast:1 row_mask:0xf bank_mask:0xf
    v_rcp_f32 v3, v3
    s_nop 0
    v_fmac_f32_dpp v48, v7, v50 row_newbcast:2 row_mask:0xf bank_mask:0xf
    v_mul_f32_dpp v52, v7, v52 row_newbcast:0 row_mask:0xf bank_mask:0xf
    s_nop 0
    v_fmac_f32_dpp v48, v7, v51 row_newbcast:3 row_mask:0xf bank_mask:0xf
    v_fmac_f32_dpp v52, v7, v53 row_newbcast:1 row_mask:0xf bank_mask:0xf
    v_mul_f32 v48, v3, v48
    s_nop 0
    v_fmac_f32_dpp v52, v7, v54 row_newbcast:2 row_mask:0xf bank_mask:0xf
    s_nop 1
    v_fmac_f32_dpp v52, v7, v55 row_newbcast:3 row_mask:0xf bank_mask:0xf
    v_mul_f32 v52, v3, v52
    ds_write2st64_b32 v5, v48, v52 offset0:0 offset1:1
    v_and_b32 v30, 31, v0
    v_lshrrev_b32 v29, 5, v0
    s_mov_b32 s39, 158720
    v_min_u32 v26, 17, v30
    v_lshl_add_u32 v26, v26, 4, s39
    v_lshl_add_u32 v26, v29, 10, v26
    v_mul_u32_u24 v29, 65536, v29
    v_lshl_add_u32 v31, v30, 2, v29
    s_and_b32 exec_lo, s50, 0xffffffff
    s_and_b32 exec_hi, s51, 0xffffffff
    s_cmp_lg_u32 s3, 2
    s_waitcnt lgkmcnt(0)
    s_barrier
    ds_read_b128 v[32:35], v26
    ds_read_b128 v[36:39], v26 offset:512
    s_waitcnt lgkmcnt(1)
    v_pk_add_f32 v[32:33], v[32:33], v[34:35]
    s_waitcnt lgkmcnt(0)
    v_pk_add_f32 v[34:35], v[36:37], v[38:39]
    v_pk_add_f32 v[32:33], v[32:33], v[34:35]
    v_add_f32 v32, v32, v33
    s_cbranch_scc1 x8_16_s
    buffer_store_dword v32, v31, s[12:15], s94 offen sc1
x8_16_s:
    s_mov_b64 exec, -1
    v_and_b32 v30, 7, v0
    v_min_u32 v30, 4, v30
    v_lshrrev_b32 v28, 3, v0
    v_mul_u32_u24 v28, 128, v28
    v_lshl_add_u32 v28, v30, 4, v28
    v_lshrrev_b32 v27, 4, v0
    v_lshlrev_b32 v27, 1, v27
    v_lshl_add_u32 v30, v30, 3, v27
    v_and_b32 v7, 15, v0
    s_mul_i32 s39, s3, 288
    v_and_b32 v2, 3, v0
    v_mul_u32_u24 v2, 1152, v2
    v_add_u32 v2, s39, v2
    v_lshrrev_b32 v44, 4, v0
    v_lshl_add_u32 v3, v44, 3, v2
    v_lshl_add_u32 v2, v44, 4, v2
    s_lshl_b32 s39, s3, 2
    s_add_u32 s39, s39, 158720
    v_lshl_add_u32 v7, v7, 4, s39
    v_bfe_u32 v44, v0, 2, 2
    v_lshl_add_u32 v2, v44, 6, v2
    v_mov_b32 v8, 0x3f803f80
    v_mov_b32 v9, 0x3f803f80
    v_mov_b32 v10, 0x3f803f80
    v_mov_b32 v11, 0x3f803f80
    v_mov_b32 v24, 0x3f803f80
    v_mov_b32 v25, 0x3f803f80
    v_bfe_u32 v4, v0, 2, 2
    s_mul_i32 s39, s3, 144
    v_add_u32 v4, s39, v4
    v_lshrrev_b32 v44, 4, v0
    v_lshl_add_u32 v5, v44, 2, v4
    v_lshl_add_u32 v4, v44, 3, v4
    v_and_b32 v44, 3, v0
    s_mov_b32 s39, 0
    v_lshl_add_u32 v44, v44, 3, s39
    s_movk_i32 s39, 72
    v_mad_u32_u24 v4, v4, s39, v44
    v_mad_u32_u24 v5, v5, s39, v44
    s_xor_b32 s39, s3, 3
    s_or_b32 s39, s39, s36
    s_cbranch_scc1 L_nolr
    v_lshlrev_b32 v40, 4, v0
    s_mul_i32 s39, s2, 1584
    s_add_u32 s39, s39, 288768
    v_mov_b32 v36, -1
    v_mov_b32 v37, -1
    v_mov_b32 v38, -1
    v_mov_b32 v39, -1
    buffer_store_dwordx4 v[36:39], v40, s[12:15], s39 offen sc1
    s_mov_b32 exec_lo, 0xffffffff
    s_mov_b32 exec_hi, 0x7
    buffer_store_dwordx4 v[36:39], v40, s[12:15], s39 offen offset:1024 sc1
    s_mov_b64 exec, -1
L_nolr:
    s_cmp_eq_u32 s60, 0
    s_cbranch_scc1 x8_16_n

x8_16:
    buffer_load_dwordx4 v[32:35], v28, s[12:15], s95 offen sc1
    s_add_u32 s41, s41, 1
    s_cmp_gt_u32 s41, 0x20000
    s_cbranch_scc1 L_end
    s_waitcnt vmcnt(0)
    v_max3_u32 v27, v32, v33, v35
    v_max3_u32 v27, v27, v34, v35
    v_cmp_eq_u32 vcc, -1, v27
    s_cbranch_vccnz x8_16
    v_permlane32_swap_b32 v32, v34
    v_permlane32_swap_b32 v33, v35
    v_add_f32 v32, v32, v34
    v_add_f32 v33, v33, v35
    s_nop 1
    v_permlane16_swap_b32 v32, v33
    v_add_f32 v32, v32, v33
    s_nop 1
    v_add_f32_dpp v32, v32, v32 row_ror:8 row_mask:0xf bank_mask:0xf
    v_cvt_pk_bf16_f32 v32, v32, v32
    v_lshlrev_b32 v32, 16, v32
    v_add_f32 v33, v1, v32
    v_add_f32 v34, v1, v32
    v_add_f32 v1, v1, v32
    s_nop 0
    v_permlane16_swap_b32 v33, v34
    v_cvt_pk_bf16_f32 v27, v33, v34
    s_mov_b32 exec_lo, 0x1f
    s_mov_b32 exec_hi, 0xf
    buffer_store_dword v27, v30, s[16:19], s99 offen
    buffer_store_dword v27, v30, s[20:23], s99 offen sc1
    s_mov_b64 exec, -1
    v_cvt_pk_bf16_f32 v1, v1, v1
    v_lshlrev_b32 v1, 16, v1
x8_16_n:
    s_barrier
    s_mov_b64 exec, s[52:53]
    buffer_load_dwordx4 v[8:11], v2, s[12:15], s98 offen offset:0 sc1
    s_and_b32 exec_lo, exec_lo, 0xf000f
    s_and_b32 exec_hi, exec_hi, 0xf000f
    buffer_load_dwordx2 v[24:25], v3, s[12:15], s98 offen offset:256 sc1
    s_mov_b64 exec, -1
    ds_read_b64_tr_b16 v[26:27], v4 offset:0
    ds_read_b64_tr_b16 v[28:29], v4 offset:288
    ds_read_b64_tr_b16 v[30:31], v4 offset:2304
    ds_read_b64_tr_b16 v[32:33], v4 offset:2592
    ds_read_b64_tr_b16 v[34:35], v4 offset:4608
    ds_read_b64_tr_b16 v[36:37], v4 offset:4896
    ds_read_b64_tr_b16 v[38:39], v4 offset:6912
    ds_read_b64_tr_b16 v[40:41], v4 offset:7200
    ds_read_b64_tr_b16 v[42:43], v5 offset:9216
    s_branch xp_17_w
xp_17:
    s_mov_b64 exec, s[52:53]
    buffer_load_dwordx4 v[8:11], v2, s[12:15], s98 offen offset:0 sc1
    s_and_b32 exec_lo, exec_lo, 0xf000f
    s_and_b32 exec_hi, exec_hi, 0xf000f
    buffer_load_dwordx2 v[24:25], v3, s[12:15], s98 offen offset:256 sc1
    s_mov_b64 exec, -1
    s_add_u32 s41, s41, 1
    s_cmp_gt_u32 s41, 0x20000
    s_cbranch_scc1 L_end
xp_17_w:
    s_waitcnt vmcnt(0)
    v_mfma_f32_16x16x16_bf16 v[52:55], v[24:25], v[24:25], 0
    v_max3_u32 v44, v8, v9, v25
    v_max3_u32 v44, v44, v10, v11
    v_max3_u32 v44, v44, v24, v25
    v_cmp_eq_u32 vcc, -1, v44
    s_cbranch_vccnz xp_17
    v_mov_b32_dpp v12, v8 row_shl:4 row_mask:0xf bank_mask:0xf bound_ctrl:1
    v_mov_b32_dpp v13, v9 row_shl:4 row_mask:0xf bank_mask:0xf bound_ctrl:1
    v_mov_b32_dpp v14, v10 row_shl:4 row_mask:0xf bank_mask:0xf bound_ctrl:1
    v_mov_b32_dpp v15, v11 row_shl:4 row_mask:0xf bank_mask:0xf bound_ctrl:1
    v_mfma_f32_16x16x32_bf16 v[52:55], v[8:11], v[8:11], v[52:55]
    v_mov_b32_dpp v16, v8 row_shl:8 row_mask:0xf bank_mask:0xf bound_ctrl:1
    v_mov_b32_dpp v17, v9 row_shl:8 row_mask:0xf bank_mask:0xf bound_ctrl:1
    v_mov_b32_dpp v18, v10 row_shl:8 row_mask:0xf bank_mask:0xf bound_ctrl:1
    v_mov_b32_dpp v19, v11 row_shl:8 row_mask:0xf bank_mask:0xf bound_ctrl:1
    v_mfma_f32_16x16x32_bf16 v[52:55], v[12:15], v[12:15], v[52:55]
    v_mov_b32_dpp v20, v8 row_shl:12 row_mask:0xf bank_mask:0xf bound_ctrl:1
    v_mov_b32_dpp v21, v9 row_shl:12 row_mask:0xf bank_mask:0xf bound_ctrl:1
    v_mov_b32_dpp v22, v10 row_shl:12 row_mask:0xf bank_mask:0xf bound_ctrl:1
    v_mov_b32_dpp v23, v11 row_shl:12 row_mask:0xf bank_mask:0xf bound_ctrl:1
    v_mfma_f32_16x16x32_bf16 v[52:55], v[16:19], v[16:19], v[52:55]
    s_nop 0
    v_mfma_f32_16x16x32_bf16 v[52:55], v[20:23], v[20:23], v[52:55]
    s_waitcnt lgkmcnt(0)
    v_mfma_f32_16x16x32_bf16 v[44:47], v[8:11], v[26:29], 0
    ds_read_b64_tr_b16 v[26:27], v4 offset:32
    ds_read_b64_tr_b16 v[28:29], v4 offset:320
    v_mfma_f32_16x16x32_bf16 v[44:47], v[12:15], v[30:33], v[44:47]
    ds_read_b64_tr_b16 v[30:31], v4 offset:2336
    ds_read_b64_tr_b16 v[32:33], v4 offset:2624
    v_mfma_f32_16x16x32_bf16 v[44:47], v[16:19], v[34:37], v[44:47]
    ds_read_b64_tr_b16 v[34:35], v4 offset:4640
    ds_read_b64_tr_b16 v[36:37], v4 offset:4928
    v_mfma_f32_16x16x32_bf16 v[44:47], v[20:23], v[38:41], v[44:47]
    ds_read_b64_tr_b16 v[38:39], v4 offset:6944
    ds_read_b64_tr_b16 v[40:41], v4 offset:7232
    s_nop 3
    v_mfma_f32_16x16x16_bf16 v[44:47], v[24:25], v[42:43], v[44:47]
    ds_read_b64_tr_b16 v[42:43], v5 offset:9248
    s_mov_b64 exec, 0xffff
    ds_write2st64_b32 v7, v52, v53 offset0:3 offset1:7
    ds_write_b32 v7, v54 offset:2816
    s_mov_b64 exec, -1
    s_waitcnt lgkmcnt(9)
    v_mfma_f32_16x16x32_bf16 v[48:51], v[8:11], v[26:29], 0
    ds_read_b64_tr_b16 v[26:27], v4 offset:64
    ds_read_b64_tr_b16 v[28:29], v4 offset:352
    s_waitcnt lgkmcnt(9)
    v_mfma_f32_16x16x32_bf16 v[48:51], v[12:15], v[30:33], v[48:51]
    ds_read_b64_tr_b16 v[30:31], v4 offset:2368
    ds_read_b64_tr_b16 v[32:33], v4 offset:2656
    s_waitcnt lgkmcnt(9)
    v_mfma_f32_16x16x32_bf16 v[48:51], v[16:19], v[34:37], v[48:51]
    ds_read_b64_tr_b16 v[34:35], v4 offset:4672
    ds_read_b64_tr_b16 v[36:37], v4 offset:4960
    s_waitcnt lgkmcnt(9)
    v_mfma_f32_16x16x32_bf16 v[48:51], v[20:23], v[38:41], v[48:51]
    ds_read_b64_tr_b16 v[38:39], v4 offset:6976
    ds_read_b64_tr_b16 v[40:41], v4 offset:7264
    s_waitcnt lgkmcnt(10)
    s_nop 2
    v_mfma_f32_16x16x16_bf16 v[48:51], v[24:25], v[42:43], v[48:51]
    ds_read_b64_tr_b16 v[42:43], v5 offset:9280
    s_waitcnt lgkmcnt(7)
    v_mfma_f32_16x16x32_bf16 v[52:55], v[8:11], v[26:29], 0
    s_waitcnt lgkmcnt(5)
    v_mfma_f32_16x16x32_bf16 v[52:55], v[12:15], v[30:33], v[52:55]
    s_waitcnt lgkmcnt(3)
    v_mfma_f32_16x16x32_bf16 v[52:55], v[16:19], v[34:37], v[52:55]
    s_waitcnt lgkmcnt(1)
    v_mfma_f32_16x16x32_bf16 v[52:55], v[20:23], v[38:41], v[52:55]
    s_waitcnt lgkmcnt(0)
    v_lshrrev_b32 v30, 1, v0
    v_and_b32 v31, 1, v0
    s_mov_b32 s39, 158720
    v_lshl_add_u32 v27, v30, 4, s39
    v_lshl_add_u32 v26, v31, 10, v27
    v_lshl_add_u32 v29, v31, 4, s39
    v_lshl_add_u32 v28, v31, 10, v29
    v_mul_u32_u24 v31, 576, v31
    v_add_lshl_u32 v30, v30, v31, 1
    v_mfma_f32_16x16x16_bf16 v[52:55], v[24:25], v[42:43], v[52:55]
    s_mov_b64 exec, 0xffff
    ds_write2st64_b32 v7, v44, v45 offset0:0 offset1:4
    ds_write_b32 v7, v46 offset:2048
    ds_write2st64_b32 v7, v48, v49 offset0:1 offset1:5
    ds_write_b32 v7, v50 offset:2304
    s_nop 2
    ds_write2st64_b32 v7, v52, v53 offset0:2 offset1:6
    ds_write_b32 v7, v54 offset:2560
    s_mov_b64 exec, -1
    s_waitcnt lgkmcnt(0)
    s_barrier
    s_cmp_lg_u32 s3, 0
    s_cbranch_scc1 w0_18
    s_mov_b64 exec, s[54:55]
    ds_read_b128 v[36:39], v29 offset:2816
    ds_read_b128 v[32:35], v28 offset:768
    ds_read_b128 v[40:43], v26
    ds_read_b128 v[44:47], v27 offset:2048
    ds_read_b128 v[48:51], v26 offset:288
    ds_read_b128 v[52:55], v27 offset:2336
    s_mov_b32 s82, 0x3ae38e39
    s_mov_b32 s83, 0xbdd2d3e8
    v_mov_b32 v31, 0xc0135761
    s_waitcnt lgkmcnt(4)
    v_pk_add_f32 v[36:37], v[36:37], v[38:39]
    v_add_f32 v36, v36, v37
    v_pk_add_f32 v[32:33], v[32:33], v[34:35]
    v_add_f32 v32, v32, v33
    v_mul_f32 v36, 0xbae38e39, v36
    v_mul_f32 v33, v36, v36
    v_fma_f32 v32, v32, s82, -v33
    v_max_f32 v32, 0, v32
    v_add_f32 v32, 0x3727c5ac, v32
    v_rsq_f32 v32, v32
    s_waitcnt lgkmcnt(2)
    v_pk_add_f32 v[40:41], v[40:41], v[42:43]
    v_add_f32 v40, v40, v41
    v_pk_add_f32 v[44:45], v[44:45], v[46:47]
    v_add_f32 v44, v44, v45
    v_fma_f32 v40, v36, v44, v40
    v_mul_f32 v40, v40, v32
    v_mul_f32 v41, v40, v40
    v_fma_f32 v41, v41, s83, v31
    v_mul_f32 v41, v41, v40
    v_exp_f32 v41, v41
    s_waitcnt lgkmcnt(0)
    v_pk_add_f32 v[48:49], v[48:49], v[50:51]
    v_add_f32 v48, v48, v49
    v_add_f32 v41, 1.0, v41
    v_rcp_f32 v41, v41
    v_pk_add_f32 v[52:53], v[52:53], v[54:55]
    v_add_f32 v52, v52, v53
    v_fma_f32 v48, v36, v52, v48
    v_mul_f32 v48, v48, v32
    v_mul_f32 v40, v40, v41
    v_mul_f32 v40, v40, v48
    s_nop 1
    v_mov_b32_dpp v41, v40 quad_perm:[2,3,2,3] row_mask:0xf bank_mask:0xf
    v_cvt_pk_bf16_f32 v40, v40, v41
    s_mov_b64 exec, s[56:57]
    buffer_store_dword v40, v30, s[16:19], s101 offen
    buffer_store_dword v40, v30, s[20:23], s101 offen sc1
w0_18:
    s_mov_b64 exec, -1
    s_barrier
    s_mov_b64 exec, s[52:53]
    buffer_load_dwordx4 v[8:11], v2, s[12:15], s100 offen offset:0 sc1
    s_and_b32 exec_lo, exec_lo, 0xf000f
    s_and_b32 exec_hi, exec_hi, 0xf000f
    buffer_load_dwordx2 v[24:25], v3, s[12:15], s100 offen offset:256 sc1
    s_mov_b64 exec, -1
    ds_read_b64_tr_b16 v[26:27], v4 offset:41504
    ds_read_b64_tr_b16 v[28:29], v4 offset:41792
    ds_read_b64_tr_b16 v[30:31], v4 offset:43808
    ds_read_b64_tr_b16 v[32:33], v4 offset:44096
    ds_read_b64_tr_b16 v[34:35], v4 offset:46112
    ds_read_b64_tr_b16 v[36:37], v4 offset:46400
    ds_read_b64_tr_b16 v[38:39], v4 offset:48416
    ds_read_b64_tr_b16 v[40:41], v4 offset:48704
    ds_read_b64_tr_b16 v[42:43], v5 offset:50720
    s_branch xp_19_w
xp_19:
    s_mov_b64 exec, s[52:53]
    buffer_load_dwordx4 v[8:11], v2, s[12:15], s100 offen offset:0 sc1
    s_and_b32 exec_lo, exec_lo, 0xf000f
    s_and_b32 exec_hi, exec_hi, 0xf000f
    buffer_load_dwordx2 v[24:25], v3, s[12:15], s100 offen offset:256 sc1
    s_mov_b64 exec, -1
    s_add_u32 s41, s41, 1
    s_cmp_gt_u32 s41, 0x20000
    s_cbranch_scc1 L_end
xp_19_w:
    s_waitcnt vmcnt(0)
    v_max3_u32 v44, v8, v9, v25
    v_max3_u32 v44, v44, v10, v11
    v_max3_u32 v44, v44, v24, v25
    v_cmp_eq_u32 vcc, -1, v44
    s_cbranch_vccnz xp_19
    v_mov_b32_dpp v12, v8 row_shl:4 row_mask:0xf bank_mask:0xf bound_ctrl:1
    v_mov_b32_dpp v13, v9 row_shl:4 row_mask:0xf bank_mask:0xf bound_ctrl:1
    v_mov_b32_dpp v14, v10 row_shl:4 row_mask:0xf bank_mask:0xf bound_ctrl:1
    v_mov_b32_dpp v15, v11 row_shl:4 row_mask:0xf bank_mask:0xf bound_ctrl:1
    s_waitcnt lgkmcnt(0)
    v_mfma_f32_16x16x32_bf16 v[44:47], v[8:11], v[26:29], 0
    v_mov_b32_dpp v16, v8 row_shl:8 row_mask:0xf bank_mask:0xf bound_ctrl:1
    v_mov_b32_dpp v17, v9 row_shl:8 row_mask:0xf bank_mask:0xf bound_ctrl:1
    v_mov_b32_dpp v18, v10 row_shl:8 row_mask:0xf bank_mask:0xf bound_ctrl:1
    v_mov_b32_dpp v19, v11 row_shl:8 row_mask:0xf bank_mask:0xf bound_ctrl:1
    ds_read_b64_tr_b16 v[26:27], v4 offset:41536
    ds_read_b64_tr_b16 v[28:29], v4 offset:41824
    v_mfma_f32_16x16x32_bf16 v[44:47], v[12:15], v[30:33], v[44:47]
    v_mov_b32_dpp v20, v8 row_shl:12 row_mask:0xf bank_mask:0xf bound_ctrl:1
    v_mov_b32_dpp v21, v9 row_shl:12 row_mask:0xf bank_mask:0xf bound_ctrl:1
    v_mov_b32_dpp v22, v10 row_shl:12 row_mask:0xf bank_mask:0xf bound_ctrl:1
    v_mov_b32_dpp v23, v11 row_shl:12 row_mask:0xf bank_mask:0xf bound_ctrl:1
    ds_read_b64_tr_b16 v[30:31], v4 offset:43840
    ds_read_b64_tr_b16 v[32:33], v4 offset:44128
    v_mfma_f32_16x16x32_bf16 v[44:47], v[16:19], v[34:37], v[44:47]
    ds_read_b64_tr_b16 v[34:35], v4 offset:46144
    ds_read_b64_tr_b16 v[36:37], v4 offset:46432
    v_mfma_f32_16x16x32_bf16 v[44:47], v[20:23], v[38:41], v[44:47]
    ds_read_b64_tr_b16 v[38:39], v4 offset:48448
    ds_read_b64_tr_b16 v[40:41], v4 offset:48736
    s_nop 3
    v_mfma_f32_16x16x16_bf16 v[44:47], v[24:25], v[42:43], v[44:47]
    ds_read_b64_tr_b16 v[42:43], v5 offset:50752
    s_waitcnt lgkmcnt(7)
    v_mfma_f32_16x16x32_bf16 v[48:51], v[8:11], v[26:29], 0
    s_waitcnt lgkmcnt(5)
    v_mfma_f32_16x16x32_bf16 v[48:51], v[12:15], v[30:33], v[48:51]
    s_waitcnt lgkmcnt(3)
    v_mfma_f32_16x16x32_bf16 v[48:51], v[16:19], v[34:37], v[48:51]
    s_waitcnt lgkmcnt(1)
    v_mfma_f32_16x16x32_bf16 v[48:51], v[20:23], v[38:41], v[48:51]
    s_waitcnt lgkmcnt(0)
    v_and_b32 v30, 31, v0
    v_lshrrev_b32 v29, 5, v0
    s_mov_b32 s39, 158720
    v_min_u32 v26, 17, v30
    v_lshl_add_u32 v26, v26, 4, s39
    v_lshl_add_u32 v26, v29, 10, v26
    v_mul_u32_u24 v29, 65536, v29
    v_lshl_add_u32 v31, v30, 2, v29
    v_mfma_f32_16x16x16_bf16 v[48:51], v[24:25], v[42:43], v[48:51]
    s_mov_b64 exec, 0xffff
    ds_write2st64_b32 v7, v44, v45 offset0:0 offset1:4
    s_nop 5
    ds_write2st64_b32 v7, v48, v49 offset0:1 offset1:5
    s_mov_b64 exec, -1
    s_and_b32 exec_lo, s50, 0xffffffff
    s_and_b32 exec_hi, s51, 0xffffffff
    s_cmp_lg_u32 s3, 2
    s_waitcnt lgkmcnt(0)
    s_barrier
    ds_read_b128 v[32:35], v26 offset:32
    s_waitcnt lgkmcnt(0)
    v_pk_add_f32 v[32:33], v[32:33], v[34:35]
    v_add_f32 v32, v32, v33
    s_cbranch_scc1 x8_20_s
    buffer_store_dword v32, v31, s[12:15], s96 offen sc1
x8_20_s:
    s_mov_b64 exec, -1
    v_and_b32 v30, 7, v0
    v_min_u32 v30, 4, v30
    v_lshrrev_b32 v28, 3, v0
    v_mul_u32_u24 v28, 128, v28
    v_lshl_add_u32 v28, v30, 4, v28
    v_lshrrev_b32 v27, 4, v0
    v_lshlrev_b32 v27, 1, v27
    v_lshl_add_u32 v30, v30, 3, v27
    v_bfe_u32 v4, v0, 2, 2
    s_mul_i32 s39, s3, 144
    v_add_u32 v4, s39, v4
    v_lshrrev_b32 v44, 4, v0
    v_lshl_add_u32 v5, v44, 2, v4
    v_lshl_add_u32 v4, v44, 3, v4
    v_and_b32 v44, 3, v0
    s_mov_b32 s39, 82944
    v_lshl_add_u32 v44, v44, 3, s39
    s_movk_i32 s39, 32
    v_mad_u32_u24 v4, v4, s39, v44
    v_mad_u32_u24 v5, v5, s39, v44
    s_cmp_eq_u32 s67, 0
    s_cbranch_scc1 x8_20_n

x8_20:
    buffer_load_dwordx4 v[32:35], v28, s[12:15], s97 offen sc1
    s_add_u32 s41, s41, 1
    s_cmp_gt_u32 s41, 0x20000
    s_cbranch_scc1 L_end
    s_waitcnt vmcnt(0)
    v_max3_u32 v27, v32, v33, v35
    v_max3_u32 v27, v27, v34, v35
    v_cmp_eq_u32 vcc, -1, v27
    s_cbranch_vccnz x8_20
    v_permlane32_swap_b32 v32, v34
    v_permlane32_swap_b32 v33, v35
    v_add_f32 v32, v32, v34
    v_add_f32 v33, v33, v35
    s_nop 1
    v_permlane16_swap_b32 v32, v33
    v_add_f32 v32, v32, v33
    s_nop 1
    v_add_f32_dpp v32, v32, v32 row_ror:8 row_mask:0xf bank_mask:0xf
    v_cvt_pk_bf16_f32 v32, v32, v32
    v_lshlrev_b32 v32, 16, v32
    v_add_f32 v33, v1, v32
    v_add_f32 v34, v1, v32
    v_add_f32 v1, v1, v32
    s_nop 0
    v_permlane16_swap_b32 v33, v34
    v_cvt_pk_bf16_f32 v27, v33, v34
    s_mov_b32 exec_lo, 0x1f
    s_mov_b32 exec_hi, 0xf
    s_cmp_eq_u32 s61, 0
    s_cbranch_scc1 L_nox2
    buffer_store_dword v27, v30, s[16:19], s29 offen
    buffer_store_dword v27, v30, s[20:23], s29 offen sc1
L_nox2:
    s_cmp_eq_u32 s66, 0
    s_cbranch_scc1 L_noout
    buffer_store_dword v27, v30, s[24:27], s85 offen
L_noout:
    s_mov_b64 exec, -1
    v_cvt_pk_bf16_f32 v1, v1, v1
    v_lshlrev_b32 v1, 16, v1
x8_20_n:
    s_cmp_eq_u32 s36, 2
    s_cbranch_scc1 L_end
    s_barrier
    s_mov_b64 exec, s[58:59]
    buffer_load_dwordx4 v[8:11], v2, s[12:15], s28 offen offset:0 sc1
    s_and_b32 exec_lo, exec_lo, 0xf000f
    s_and_b32 exec_hi, exec_hi, 0xf000f
    buffer_load_dwordx2 v[24:25], v3, s[12:15], s28 offen offset:256 sc1
    s_mov_b64 exec, -1
    ds_read_b64_tr_b16 v[26:27], v4 offset:0
    ds_read_b64_tr_b16 v[28:29], v4 offset:128
    ds_read_b64_tr_b16 v[30:31], v4 offset:1024
    ds_read_b64_tr_b16 v[32:33], v4 offset:1152
    ds_read_b64_tr_b16 v[34:35], v4 offset:2048
    ds_read_b64_tr_b16 v[36:37], v4 offset:2176
    ds_read_b64_tr_b16 v[38:39], v4 offset:3072
    ds_read_b64_tr_b16 v[40:41], v4 offset:3200
    ds_read_b64_tr_b16 v[42:43], v5 offset:4096
    s_branch xp_21_w
xp_21:
    s_mov_b64 exec, s[58:59]
    buffer_load_dwordx4 v[8:11], v2, s[12:15], s28 offen offset:0 sc1
    s_and_b32 exec_lo, exec_lo, 0xf000f
    s_and_b32 exec_hi, exec_hi, 0xf000f
    buffer_load_dwordx2 v[24:25], v3, s[12:15], s28 offen offset:256 sc1
    s_mov_b64 exec, -1
    s_add_u32 s41, s41, 1
    s_cmp_gt_u32 s41, 0x20000
    s_cbranch_scc1 L_end
xp_21_w:
    s_waitcnt vmcnt(0)
    v_mfma_f32_16x16x16_bf16 v[52:55], v[24:25], v[24:25], 0
    v_max3_u32 v44, v8, v9, v25
    v_max3_u32 v44, v44, v10, v11
    v_max3_u32 v44, v44, v24, v25
    v_cmp_eq_u32 vcc, -1, v44
    s_cbranch_vccnz xp_21
    v_mov_b32_dpp v12, v8 row_shl:4 row_mask:0xf bank_mask:0xf bound_ctrl:1
    v_mov_b32_dpp v13, v9 row_shl:4 row_mask:0xf bank_mask:0xf bound_ctrl:1
    v_mov_b32_dpp v14, v10 row_shl:4 row_mask:0xf bank_mask:0xf bound_ctrl:1
    v_mov_b32_dpp v15, v11 row_shl:4 row_mask:0xf bank_mask:0xf bound_ctrl:1
    v_mfma_f32_16x16x32_bf16 v[52:55], v[8:11], v[8:11], v[52:55]
    v_mov_b32_dpp v16, v8 row_shl:8 row_mask:0xf bank_mask:0xf bound_ctrl:1
    v_mov_b32_dpp v17, v9 row_shl:8 row_mask:0xf bank_mask:0xf bound_ctrl:1
    v_mov_b32_dpp v18, v10 row_shl:8 row_mask:0xf bank_mask:0xf bound_ctrl:1
    v_mov_b32_dpp v19, v11 row_shl:8 row_mask:0xf bank_mask:0xf bound_ctrl:1
    v_mfma_f32_16x16x32_bf16 v[52:55], v[12:15], v[12:15], v[52:55]
    v_mov_b32_dpp v20, v8 row_shl:12 row_mask:0xf bank_mask:0xf bound_ctrl:1
    v_mov_b32_dpp v21, v9 row_shl:12 row_mask:0xf bank_mask:0xf bound_ctrl:1
    v_mov_b32_dpp v22, v10 row_shl:12 row_mask:0xf bank_mask:0xf bound_ctrl:1
    v_mov_b32_dpp v23, v11 row_shl:12 row_mask:0xf bank_mask:0xf bound_ctrl:1
    v_mfma_f32_16x16x32_bf16 v[52:55], v[16:19], v[16:19], v[52:55]
    s_nop 0
    v_mfma_f32_16x16x32_bf16 v[52:55], v[20:23], v[20:23], v[52:55]
    s_waitcnt lgkmcnt(0)
    v_mfma_f32_16x16x32_bf16 v[44:47], v[8:11], v[26:29], 0
    v_mfma_f32_16x16x32_bf16 v[44:47], v[12:15], v[30:33], v[44:47]
    v_mfma_f32_16x16x32_bf16 v[44:47], v[16:19], v[34:37], v[44:47]
    v_mfma_f32_16x16x32_bf16 v[44:47], v[20:23], v[38:41], v[44:47]
    v_lshrrev_b32 v30, 1, v0
    v_and_b32 v31, 1, v0
    s_mov_b32 s39, 158720
    v_lshl_add_u32 v27, v30, 4, s39
    v_lshl_add_u32 v26, v31, 10, v27
    v_lshl_add_u32 v29, v31, 4, s39
    v_lshl_add_u32 v28, v31, 10, v29
    v_mul_u32_u24 v31, 576, v31
    v_add_lshl_u32 v30, v30, v31, 1
    v_mfma_f32_16x16x16_bf16 v[44:47], v[24:25], v[42:43], v[44:47]
    s_mov_b64 exec, 0xffff
    ds_write2st64_b32 v7, v52, v53 offset0:3 offset1:7
    ds_write_b32 v7, v54 offset:2816
    s_mov_b64 exec, -1
    s_mov_b64 exec, 0xffff
    s_nop 2
    ds_write2st64_b32 v7, v44, v45 offset0:0 offset1:4
    ds_write_b32 v7, v46 offset:2048
    s_mov_b64 exec, -1
    v_lshrrev_b32 v48, 4, v0
    v_and_b32 v49, 3, v0
    v_lshlrev_b32 v49, 4, v49
    v_lshl_add_u32 v48, v48, 6, v49
    s_waitcnt lgkmcnt(0)
    s_barrier
    s_cmp_lg_u32 s3, 0
    s_cbranch_scc1 w0_22
    s_mov_b64 exec, s[62:63]
    ds_read_b128 v[36:39], v29 offset:2816
    ds_read_b128 v[32:35], v28 offset:768
    ds_read_b128 v[40:43], v26
    ds_read_b128 v[44:47], v27 offset:2048
    s_mov_b32 s82, 0x3ae38e39
    v_and_b32 v31, 1, v0
    v_lshrrev_b32 v30, 1, v0
    v_lshlrev_b32 v31, 7, v31
    v_add_lshl_u32 v30, v30, v31, 1
    s_waitcnt lgkmcnt(2)
    v_pk_add_f32 v[36:37], v[36:37], v[38:39]
    v_add_f32 v36, v36, v37
    v_pk_add_f32 v[32:33], v[32:33], v[34:35]
    v_add_f32 v32, v32, v33
    v_mul_f32 v36, 0xbae38e39, v36
    v_mul_f32 v33, v36, v36
    v_fma_f32 v32, v32, s82, -v33
    v_max_f32 v32, 0, v32
    v_add_f32 v32, 0x3727c5ac, v32
    v_rsq_f32 v32, v32
    s_waitcnt lgkmcnt(0)
    v_pk_add_f32 v[40:41], v[40:41], v[42:43]
    v_add_f32 v40, v40, v41
    v_pk_add_f32 v[44:45], v[44:45], v[46:47]
    v_add_f32 v44, v44, v45
    v_fma_f32 v40, v36, v44, v40
    v_mul_f32 v40, v40, v32
    s_nop 1
    v_mov_b32_dpp v41, v40 quad_perm:[2,3,2,3] row_mask:0xf bank_mask:0xf
    v_cvt_pk_bf16_f32 v40, v40, v41
    s_mov_b64 exec, s[64:65]
    buffer_store_dword v40, v30, s[16:19], s30 offen
    buffer_store_dword v40, v30, s[20:23], s30 offen sc1
w0_22:
    s_mov_b64 exec, -1
    s_barrier
    buffer_load_dwordx4 v[24:27], v48, s[12:15], s31 offen sc1
    s_mov_b32 s46, s31
    v_bfe_u32 v2, v0, 2, 2
    v_lshl_add_u32 v2, v2, 8, s44
    v_lshrrev_b32 v7, 4, v0
    v_lshl_add_u32 v2, v7, 6, v2
    v_and_b32 v7, 3, v0
    v_lshl_add_u32 v2, v7, 4, v2
    v_lshl_add_u32 v3, v0, 4, s44
    v_lshl_add_u32 v4, v0, 4, s45
    v_and_b32 v7, 1, v0
    v_lshlrev_b32 v7, 4, v7
    s_mov_b32 s39, 0xffff
    v_lshlrev_b32 v7, v7, s39
    v_bfe_u32 v5, v0, 1, 2
    v_cmp_eq_u32 vcc, 0, v5
    s_nop 1
    v_cndmask_b32 v52, 0, v7, vcc
    v_cmp_eq_u32 vcc, 1, v5
    s_nop 1
    v_cndmask_b32 v53, 0, v7, vcc
    v_cmp_eq_u32 vcc, 2, v5
    s_nop 1
    v_cndmask_b32 v54, 0, v7, vcc
    v_cmp_eq_u32 vcc, 3, v5
    s_nop 1
    v_cndmask_b32 v55, 0, v7, vcc
    s_cmp_eq_u32 s36, 0
    s_cselect_b32 s40, 1, -1
    s_mul_i32 s40, s40, 485376
    s_add_u32 s31, s31, 256
    s_add_u32 s90, s90, s40
    s_add_u32 s91, s91, s40
    s_add_u32 s92, s92, s40
    s_add_u32 s93, s93, s40
    s_add_u32 s94, s94, 65536
    s_add_u32 s95, s95, 65536
    s_add_u32 s96, s96, 65536
    s_add_u32 s97, s97, 65536
    s_add_u32 s98, s98, s40
    s_add_u32 s99, s99, s40
    s_add_u32 s100, s100, s40
    s_add_u32 s101, s101, s40
    s_add_u32 s28, s28, s40
    s_add_u32 s29, s29, s40
    s_add_u32 s30, s30, s40
    s_add_u32 s31, s31, s40
    s_add_u32 s36, s36, 1
    s_mov_b32 s42, s36
    s_mov_b32 s38, 0x4000000
    s_cmp_eq_u32 s36, 2
    s_cbranch_scc1 L_mk2
    s_mov_b32 s48, 0xffffffff
    s_mov_b32 s49, 0xffffffff
    s_mov_b32 s50, 0xffffffff
    s_mov_b32 s51, 0xffffffff
    s_mov_b32 s52, 0x33333333
    s_mov_b32 s53, 0x33333333
    s_mov_b32 s54, 0xffffffff
    s_mov_b32 s55, 0xff
    s_mov_b32 s56, 0x33333333
    s_mov_b32 s57, 0x3
    s_lshr_b32 s60, 3, s3
    s_and_b32 s60, s60, 1
    s_lshr_b32 s61, 2, s3
    s_and_b32 s61, s61, 1
    s_lshr_b32 s66, 1, s3
    s_and_b32 s66, s66, 1
    s_cmp_eq_u32 s32, s35
    s_cselect_b32 s66, s66, 0
    s_or_b32 s67, s66, s61
    s_mov_b32 s58, 0x22222222
    s_mov_b32 s59, 0x22222222
    s_mov_b32 s62, 0xaaaaaaaa
    s_mov_b32 s63, 0x0
    s_mov_b32 s64, 0x22222222
    s_mov_b32 s65, 0x0
    s_branch L_qp_w
L_mk2:
    s_mov_b32 s48, 0xff00ff00
    s_mov_b32 s49, 0xff00ff00
    s_mov_b32 s50, 0x0
    s_mov_b32 s51, 0xffffffff
    s_mov_b32 s52, 0x22222222
    s_mov_b32 s53, 0x22222222
    s_mov_b32 s54, 0xaaaaaaaa
    s_mov_b32 s55, 0xaa
    s_mov_b32 s56, 0x22222222
    s_mov_b32 s57, 0x2
    s_lshr_b32 s60, 2, s3
    s_and_b32 s60, s60, 1
    s_lshr_b32 s61, 0, s3
    s_and_b32 s61, s61, 1
    s_lshr_b32 s66, 2, s3
    s_and_b32 s66, s66, 1
    s_cmp_eq_u32 s32, s35
    s_cselect_b32 s66, s66, 0
    s_or_b32 s67, s66, s61
    s_branch L_qp_w
L_qp:
    buffer_load_dwordx4 v[24:27], v48, s[12:15], s46 offen sc1
    s_add_u32 s41, s41, 1
    s_cmp_gt_u32 s41, 0x20000
    s_cbranch_scc1 L_end
L_qp_w:
    s_waitcnt vmcnt(0)
    v_max3_u32 v7, v24, v25, v27
    v_max3_u32 v7, v7, v26, v27
    v_cmp_eq_u32 vcc, -1, v7
    s_cbranch_vccz L_attn
    s_branch L_qp
L_end:
    s_waitcnt vmcnt(0)
L_exit:
    s_endpgm
.section .rodata,"a"
.p2align 6
.amdhsa_kernel interleave_layers__mha_block_cached__glu_gated_geglu__decode_kernel
  .amdhsa_next_free_vgpr 512
  .amdhsa_next_free_sgpr 102
  .amdhsa_accum_offset 256
  .amdhsa_group_segment_fixed_size 0
  .amdhsa_kernarg_size 96
  .amdhsa_user_sgpr_count 2
  .amdhsa_user_sgpr_kernarg_segment_ptr 1
  .amdhsa_system_sgpr_workgroup_id_x 1
.end_amdhsa_kernel
```
